```python
import torch

def _softmax(x, axis=-1):
    return torch.softmax(x, dim=axis)
def _gelu(x):
    return torch.nn.functional.gelu(x, approximate="tanh")
def _silu(x):
    return torch.nn.functional.silu(x)
def _sigmoid(x):
    return torch.sigmoid(x)
def _layernorm(x, axis=-1, eps=1e-5):
    m = x.mean(dim=axis, keepdim=True)
    v = x.var(dim=axis, keepdim=True, unbiased=False)
    return (x - m) / torch.sqrt(v + eps)
def _scatter_add(tgt, idx, src, axis=0):
    return tgt.clone().index_add_(axis, idx, src)
def _segment_sum(src, seg, n):
    out = torch.zeros((n,) + src.shape[1:], dtype=src.dtype)
    return out.index_add_(0, seg, src)
def _pad(x, pw):
    flat = tuple(v for pair in reversed(pw) for v in pair)
    return torch.nn.functional.pad(x, flat)

kernel_name = 'recurrent_scan__sliding_block_cached__dense_activation_relu__decode'

def setup_inputs():

    _w = (lambda a: (lambda t: t.to(torch.bfloat16) if t.is_floating_point() else t)(torch.as_tensor(a)))
    def _A_setup():
        B, Sq, D = 4, 1, 512
        Hq, Hkv, Sk, Dh = 32, 8, 16384, 128
        assert Hq % Hkv == 0, (Hq, Hkv)
        return {
            "x": _w((lambda *s: torch.randn(*s, dtype=torch.bfloat16) * 0.05)(B, Sq, D)),
            "k_cache": _w((lambda *s: torch.randn(*s, dtype=torch.bfloat16) * 1.6)(B, Hkv, Sk, Dh)),
            "v_cache": _w((lambda *s: torch.randn(*s, dtype=torch.bfloat16) * 0.2)(B, Hkv, Sk, Dh)),
            "wq": _w((lambda *s: torch.randn(*s, dtype=torch.bfloat16) * 1.6)(D, Hq * Dh) * (D ** -0.5)),
            "wo": _w((lambda *s: torch.randn(*s, dtype=torch.bfloat16) * 0.2)(Hq * Dh, D) * ((Hq * Dh) ** -0.5)),
        }
    _A_in = _A_setup()

    def _B_setup():
        B, S, D, Dff = 4, 1, 512, 1792
        return {
            "x": _w((lambda *s: torch.randn(*s, dtype=torch.bfloat16) * 0.05)(B, S, D)),
            "w1": _w((lambda *s: torch.randn(*s, dtype=torch.bfloat16) * 0.1)(D, Dff)),
            "w2": _w((lambda *s: torch.randn(*s, dtype=torch.bfloat16) * 0.1)(Dff, D)),
        }
    _B_in = _B_setup()

    return {
        "A_x": _A_in["x"],
        "A_k_cache": _A_in["k_cache"],
        "A_v_cache": _A_in["v_cache"],
        "A_wq": _A_in["wq"],
        "A_wo": _A_in["wo"],
        "B_x": _B_in["x"],
        "B_w1": _B_in["w1"],
        "B_w2": _B_in["w2"],
    }

def reference(A_x, A_k_cache, A_v_cache, A_wq, A_wo, B_x, B_w1, B_w2):
    def _A_ref(x, k_cache, v_cache, wq, wo):
        B, Sq, D = x.shape
        Hq, Dh = 32, 128
        Hkv, Sk = k_cache.shape[1], k_cache.shape[2]
        W = min(4096, max(256, Sk // 4))
        rep = Hq // Hkv
        q = (lambda x, *d: x.permute(*d))((x @ wq).reshape(B, Sq, Hq, Dh), 0, 2, 1, 3)
        k = (lambda x, n, axis: torch.repeat_interleave(x, n, dim=axis))(k_cache[:, :, Sk - W:, :], rep, axis=1)
        v = (lambda x, n, axis: torch.repeat_interleave(x, n, dim=axis))(v_cache[:, :, Sk - W:, :], rep, axis=1)
        scores = torch.einsum("bhqd,bhkd->bhqk", q, k) * (Dh ** -0.5)
        p = _softmax(scores, axis=-1)
        o = torch.einsum("bhqk,bhkd->bhqd", p, v)
        return (lambda x, *d: x.permute(*d))(o, 0, 2, 1, 3).reshape(B, Sq, Hq * Dh) @ wo

    def _B_ref(x, w1, w2):
        h = torch.einsum("bsd,df->bsf", x, w1)
        zero = torch.zeros_like(h)
        h = torch.maximum(h, zero)
        return torch.einsum("bsf,fd->bsd", h, w2)

    x = A_x
    xn = _layernorm(x, axis=-1)
    s = _A_ref(xn, A_k_cache, A_v_cache, A_wq, A_wo)
    g = _silu(_B_ref(xn, B_w1, B_w2))
    return x + s * g
```

```asm
; @launch grid=(256,1,1) block=(512,1,1) lds=163840
.amdgcn_target "amdgcn-amd-amdhsa--gfx950"
.text
.globl recurrent_scan__sliding_block_cached__dense_activation_relu__decode_kernel
.p2align 8
.type recurrent_scan__sliding_block_cached__dense_activation_relu__decode_kernel,@function
recurrent_scan__sliding_block_cached__dense_activation_relu__decode_kernel:
    s_cmp_ge_u32 s2, 256
    s_cbranch_scc1 L_end
    s_load_dwordx16 s[4:19], s[0:1], 0
    v_lshrrev_b32 v1, 6, v0
    s_and_b32 s26, s2, 7
    s_lshr_b32 s27, s2, 3
    v_readfirstlane_b32 s28, v1
    s_cmp_lt_u32 s2, 8
    s_cbranch_scc0 L_nopf
    s_getpc_b64 s[60:61]
L_pc:
    s_sub_u32 s60, s60, L_pc-recurrent_scan__sliding_block_cached__dense_activation_relu__decode_kernel
    s_subb_u32 s61, s61, 0
    v_lshlrev_b32 v1, 4, v0
    global_load_dword v255, v1, s[60:61]
    v_add_u32 v1, 0x2000, v1
    global_load_dword v255, v1, s[60:61]
L_nopf:
    v_and_b32 v0, 63, v0
    s_lshr_b32 s29, s27, 3
    s_and_b32 s30, s27, 7
    v_lshrrev_b32 v1, 4, v0
    v_and_b32 v2, 15, v0
    s_cmp_lt_u32 s28, 4
    s_cbranch_scc1 L_H
    s_sub_u32 s52, s28, 4
    s_lshl_b32 s54, s29, 25
    s_lshl_b32 s55, s26, 22
    s_add_u32 s54, s54, s55
    s_lshl_b32 s55, s30, 17
    s_add_u32 s54, s54, s55
    s_add_u32 s54, s54, 0x300000
    s_add_u32 s53, s26, s27
    s_add_u32 s53, s53, s52
    s_and_b32 s53, s53, 31
    s_lshl_b32 s53, s53, 12
    v_lshlrev_b32 v3, 2, v1
    v_xor_b32 v3, v2, v3
    v_lshlrev_b32 v3, 4, v3
    v_lshl_add_u32 v4, v1, 8, v3
    v_xor_b32 v5, 16, v4
    v_xor_b32 v6, 32, v4
    v_xor_b32 v7, 48, v4
    s_lshl_b32 s56, s52, 15
    s_mov_b32 m0, s56
    s_mov_b32 s34, 0x20000
    s_mov_b32 s35, 0x20000
    s_waitcnt lgkmcnt(0)
    s_add_u32 s32, s6, s54
    s_addc_u32 s33, s7, 0
    buffer_load_dwordx4 v4, s[32:35], s53 offen offset:0 nt lds
    buffer_load_dwordx4 v5, s[32:35], s53 offen offset:1024 nt lds
    buffer_load_dwordx4 v6, s[32:35], s53 offen offset:2048 nt lds
    buffer_load_dwordx4 v7, s[32:35], s53 offen offset:3072 nt lds
    s_load_dwordx4 s[20:23], s[0:1], 64
    s_load_dwordx2 s[24:25], s[0:1], 80
    s_mov_b32 s96, 0xffff0000
    v_mov_b32 v9, 0
    s_sub_u32 s70, s27, 16
    s_lshl_b32 s70, s70, 3
    s_add_u32 s70, s70, s26
    s_cmp_lt_u32 s27, 16
    s_cselect_b32 s71, s29, s70
    s_and_b32 s71, s71, 1
    s_lshr_b32 s70, s70, 1
    s_and_b32 s68, s27, 1
    s_cmp_ge_u32 s27, 30
    s_cselect_b32 s71, s68, s71
    s_cselect_b32 s68, 3, 0
    s_and_b32 s3, s27, 0x17
    s_cmp_eq_u32 s3, 3
    s_cselect_b32 s3, 1, s68
    s_sub_u32 s66, s27, 23
    s_lshl_b32 s60, s71, 2
    s_add_u32 s60, s60, s52
    s_lshl_b32 s60, s60, 6
    s_mul_i32 s61, s52, 48
    s_lshl_b32 s62, s66, 8
    s_add_u32 s61, s61, s62
    s_cmp_lt_u32 s66, 7
    s_cselect_b32 s60, s61, s60
    s_cselect_b32 s67, 1, 0
    s_lshl_b32 s64, s52, 13
    s_cmp_eq_u32 s67, 1
    s_mul_i32 s63, s52, 6144
    s_cselect_b32 s63, s63, s64
    s_add_u32 s63, s63, 131072
    s_lshl_b32 s61, s26, 10
    s_lshl_b32 s62, s30, 7
    s_add_u32 s61, s61, s62
    s_mov_b32 s62, 8192
    s_mov_b32 s64, 4194304
    s_mov_b32 s44, s10
    s_mov_b32 s45, s11
    s_cmp_eq_u32 s3, 0
    s_cbranch_scc1 L_nohalf
    s_lshl_b32 s60, s71, 1
    s_lshr_b32 s61, s3, 1
    s_add_u32 s60, s60, s61
    s_lshl_b32 s60, s60, 2
    s_add_u32 s60, s60, s52
    s_lshl_b32 s60, s60, 5
    s_lshl_b32 s63, s52, 12
    s_add_u32 s63, s63, 131072
    s_lshl_b32 s61, s26, 10
    s_add_u32 s61, s61, 384
    s_branch L_et
L_nohalf:
    s_cmp_lt_u32 s27, 16
    s_cbranch_scc1 L_et
    s_lshl_b32 s61, s70, 7
    s_mov_b32 s62, 3584
    s_mov_b32 s64, 1835008
    s_mov_b32 s44, s16
    s_mov_b32 s45, s17
    s_cmp_lt_u32 s27, 23
    s_cbranch_scc1 L_et
    s_lshl_b32 s61, s26, 7
    s_mov_b32 s62, 1024
    s_mov_b32 s44, s18
    s_mov_b32 s45, s19
    s_cmp_eq_u32 s67, 1
    s_cselect_b32 s64, 1835008, 0
L_et:
    s_mul_i32 s60, s60, s62
    s_add_u32 s60, s60, s61
    s_lshl_b32 s61, s62, 3
    s_mov_b32 s46, s64
    s_mov_b32 s47, 0x20000
    s_mov_b32 s65, s62
    v_lshrrev_b32 v9, 3, v0
    v_mul_lo_u32 v9, v9, s65
    v_and_b32 v10, 7, v0
    v_lshl_add_u32 v11, v10, 4, v9
    s_mov_b32 m0, s63
    s_add_u32 s63, s63, 1024
    buffer_load_dwordx4 v11, s[44:47], s60 offen nt lds
    s_add_u32 s60, s60, s61
    s_mov_b32 m0, s63
    s_add_u32 s63, s63, 1024
    buffer_load_dwordx4 v11, s[44:47], s60 offen nt lds
    s_add_u32 s60, s60, s61
    s_mov_b32 m0, s63
    s_add_u32 s63, s63, 1024
    buffer_load_dwordx4 v11, s[44:47], s60 offen nt lds
    s_add_u32 s60, s60, s61
    s_mov_b32 m0, s63
    s_add_u32 s63, s63, 1024
    buffer_load_dwordx4 v11, s[44:47], s60 offen nt lds
    s_add_u32 s60, s60, s61
    s_cmp_eq_u32 s3, 0
    s_cbranch_scc1 L_nohalf2
    s_lshl_b32 s63, s52, 12
    s_add_u32 s63, s63, 147456
    s_mov_b32 s46, 0
L_nohalf2:
    s_mov_b32 m0, s63
    s_add_u32 s63, s63, 1024
    buffer_load_dwordx4 v11, s[44:47], s60 offen nt lds
    s_add_u32 s60, s60, s61
    s_mov_b32 m0, s63
    s_add_u32 s63, s63, 1024
    buffer_load_dwordx4 v11, s[44:47], s60 offen nt lds
    s_add_u32 s60, s60, s61
    s_cmp_eq_u32 s67, 1
    s_cbranch_scc1 L_et2
    s_mov_b32 m0, s63
    s_add_u32 s63, s63, 1024
    buffer_load_dwordx4 v11, s[44:47], s60 offen nt lds
    s_add_u32 s60, s60, s61
    s_mov_b32 m0, s63
    s_add_u32 s63, s63, 1024
    buffer_load_dwordx4 v11, s[44:47], s60 offen nt lds
    s_add_u32 s60, s60, s61
L_et2:
    s_add_u32 s36, s8, s54
    s_addc_u32 s37, s9, 0
    s_mov_b32 s38, 131072
    s_mov_b32 s39, 0x20000
    v_lshlrev_b32 v8, 4, v0
    s_mov_b32 s57, s53
    s_add_u32 s56, s56, 4096
    s_mov_b32 m0, s56
    s_add_u32 s57, s57, 16384
    s_and_b32 s57, s57, 0x1ffff
    buffer_load_dwordx4 v4, s[32:35], s57 offen offset:0 nt lds
    s_waitcnt vmcnt(9)
    buffer_load_dwordx4 v5, s[32:35], s57 offen offset:1024 nt lds
    s_waitcnt vmcnt(9)
    buffer_load_dwordx4 v6, s[32:35], s57 offen offset:2048 nt lds
    s_waitcnt vmcnt(9)
    buffer_load_dwordx4 v7, s[32:35], s57 offen offset:3072 nt lds
    s_waitcnt vmcnt(9)
    s_add_u32 s56, s56, 4096
    s_mov_b32 m0, s56
    s_add_u32 s57, s57, 16384
    s_and_b32 s57, s57, 0x1ffff
    buffer_load_dwordx4 v4, s[32:35], s57 offen offset:0 nt lds
    s_waitcnt vmcnt(9)
    buffer_load_dwordx4 v5, s[32:35], s57 offen offset:1024 nt lds
    s_waitcnt vmcnt(9)
    buffer_load_dwordx4 v6, s[32:35], s57 offen offset:2048 nt lds
    s_waitcnt vmcnt(9)
    buffer_load_dwordx4 v7, s[32:35], s57 offen offset:3072 nt lds
    s_waitcnt vmcnt(9)
    s_add_u32 s56, s56, 4096
    s_mov_b32 m0, s56
    s_add_u32 s57, s57, 16384
    s_and_b32 s57, s57, 0x1ffff
    s_waitcnt vmcnt(8)
    s_barrier
    s_mov_b32 s58, 3
L_kloop:
    buffer_load_dwordx4 v4, s[32:35], s57 offen offset:0 nt lds
    s_waitcnt vmcnt(7)
    buffer_load_dwordx4 v5, s[32:35], s57 offen offset:1024 nt lds
    s_waitcnt vmcnt(7)
    buffer_load_dwordx4 v6, s[32:35], s57 offen offset:2048 nt lds
    s_waitcnt vmcnt(7)
    buffer_load_dwordx4 v7, s[32:35], s57 offen offset:3072 nt lds
    s_waitcnt vmcnt(7)
    s_add_u32 s56, s56, 4096
    s_mov_b32 m0, s56
    s_add_u32 s57, s57, 16384
    s_and_b32 s57, s57, 0x1ffff
    s_sub_u32 s58, s58, 1
    s_cmp_lg_u32 s58, 0
    s_cbranch_scc1 L_kloop
    s_barrier
    s_mov_b32 s58, 2
L_kloop2:
    buffer_load_dwordx4 v4, s[32:35], s57 offen offset:0 nt lds
    s_waitcnt vmcnt(9)
    buffer_load_dwordx4 v5, s[32:35], s57 offen offset:1024 nt lds
    s_waitcnt vmcnt(9)
    buffer_load_dwordx4 v6, s[32:35], s57 offen offset:2048 nt lds
    s_waitcnt vmcnt(9)
    buffer_load_dwordx4 v7, s[32:35], s57 offen offset:3072 nt lds
    s_waitcnt vmcnt(9)
    s_add_u32 s56, s56, 4096
    s_mov_b32 m0, s56
    s_add_u32 s57, s57, 16384
    s_and_b32 s57, s57, 0x1ffff
    s_sub_u32 s58, s58, 1
    s_cmp_lg_u32 s58, 0
    s_cbranch_scc1 L_kloop2
    s_waitcnt lgkmcnt(0)
    s_load_dword s31, s[24:25], 0
    s_add_u32 s59, s53, 0
    s_and_b32 s59, s59, 0x1ffff
    buffer_load_dwordx4 v[128:131], v8, s[36:39], s59 offen offset:0 nt
    s_waitcnt vmcnt(9)
    buffer_load_dwordx4 v[132:135], v8, s[36:39], s59 offen offset:1024 nt
    s_waitcnt vmcnt(9)
    buffer_load_dwordx4 v[136:139], v8, s[36:39], s59 offen offset:2048 nt
    s_waitcnt vmcnt(9)
    buffer_load_dwordx4 v[140:143], v8, s[36:39], s59 offen offset:3072 nt
    s_waitcnt vmcnt(9)
    s_add_u32 s59, s53, 16384
    s_and_b32 s59, s59, 0x1ffff
    buffer_load_dwordx4 v[144:147], v8, s[36:39], s59 offen offset:0 nt
    s_waitcnt vmcnt(9)
    buffer_load_dwordx4 v[148:151], v8, s[36:39], s59 offen offset:1024 nt
    s_waitcnt vmcnt(9)
    buffer_load_dwordx4 v[152:155], v8, s[36:39], s59 offen offset:2048 nt
    s_waitcnt vmcnt(9)
    buffer_load_dwordx4 v[156:159], v8, s[36:39], s59 offen offset:3072 nt
    s_waitcnt vmcnt(9)
    s_add_u32 s59, s53, 32768
    s_and_b32 s59, s59, 0x1ffff
    buffer_load_dwordx4 v[160:163], v8, s[36:39], s59 offen offset:0 nt
    s_waitcnt vmcnt(9)
    buffer_load_dwordx4 v[164:167], v8, s[36:39], s59 offen offset:1024 nt
    s_waitcnt vmcnt(9)
    buffer_load_dwordx4 v[168:171], v8, s[36:39], s59 offen offset:2048 nt
    s_waitcnt vmcnt(9)
    buffer_load_dwordx4 v[172:175], v8, s[36:39], s59 offen offset:3072 nt
    s_waitcnt vmcnt(9)
    s_add_u32 s59, s53, 49152
    s_and_b32 s59, s59, 0x1ffff
    buffer_load_dwordx4 v[176:179], v8, s[36:39], s59 offen offset:0 nt
    s_waitcnt vmcnt(9)
    buffer_load_dwordx4 v[180:183], v8, s[36:39], s59 offen offset:1024 nt
    s_waitcnt vmcnt(9)
    buffer_load_dwordx4 v[184:187], v8, s[36:39], s59 offen offset:2048 nt
    s_waitcnt vmcnt(9)
    buffer_load_dwordx4 v[188:191], v8, s[36:39], s59 offen offset:3072 nt
    s_waitcnt vmcnt(9)
    s_mov_b32 s97, 0x3db504f3
    s_mov_b32 s98, 0x3fb8aa3b
    s_mov_b32 s99, 0x05040100
    s_mov_b32 s100, 0x07060302
    v_and_b32 v3, 3, v2
    v_lshlrev_b32 v3, 2, v3
    v_lshrrev_b32 v13, 2, v2
    v_add_u32 v3, v3, v13
    v_lshlrev_b32 v3, 8, v3
    v_xor_b32 v13, v1, v2
    v_lshl_add_u32 v3, v13, 4, v3
    s_lshl_b32 s56, s52, 15
    v_add_u32 v9, s56, v3
    v_xor_b32 v10, 64, v9
    v_xor_b32 v11, 0x80, v9
    v_xor_b32 v12, 0xc0, v9
    v_lshrrev_b32 v13, 2, v2
    v_lshlrev_b32 v13, 8, v13
    v_lshl_add_u32 v13, v1, 4, v13
    v_add_u32 v13, 155648, v13
    s_lshl_b32 s56, s52, 8
    s_add_u32 s56, s56, 156672
    v_lshlrev_b32 v14, 2, v0
    v_add_u32 v15, s56, v14
    v_add_u32 v14, 156672, v14
    s_waitcnt vmcnt(16) lgkmcnt(0)
    s_add_u32 s31, s31, 0x9e3779b9
    s_barrier
    ds_read_b128 v[16:19], v13 offset:0
    ds_read_b128 v[20:23], v13 offset:64
    ds_read_b128 v[24:27], v13 offset:128
    ds_read_b128 v[28:31], v13 offset:192
    ds_read_b128 v[32:35], v9 offset:0
    ds_read_b128 v[36:39], v10 offset:0
    ds_read_b128 v[40:43], v11 offset:0
    ds_read_b128 v[44:47], v12 offset:0
    s_add_u32 s59, s53, 65536
    s_and_b32 s59, s59, 0x1ffff
    buffer_load_dwordx4 v[192:195], v8, s[36:39], s59 offen offset:0 nt
    s_waitcnt vmcnt(9)
    ds_read_b128 v[48:51], v9 offset:4096
    ds_read_b128 v[52:55], v10 offset:4096
    ds_read_b128 v[56:59], v11 offset:4096
    ds_read_b128 v[60:63], v12 offset:4096
    s_waitcnt lgkmcnt(4)
    v_mfma_f32_16x16x32_bf16 v[64:67], v[32:35], v[16:19], 0
    v_mfma_f32_16x16x32_bf16 v[64:67], v[36:39], v[20:23], v[64:67]
    v_mfma_f32_16x16x32_bf16 v[64:67], v[40:43], v[24:27], v[64:67]
    v_mfma_f32_16x16x32_bf16 v[64:67], v[44:47], v[28:31], v[64:67]
    s_add_u32 s59, s53, 65536
    s_and_b32 s59, s59, 0x1ffff
    buffer_load_dwordx4 v[196:199], v8, s[36:39], s59 offen offset:1024 nt
    s_waitcnt vmcnt(9)
    ds_read_b128 v[32:35], v9 offset:8192
    ds_read_b128 v[36:39], v10 offset:8192
    ds_read_b128 v[40:43], v11 offset:8192
    ds_read_b128 v[44:47], v12 offset:8192
    s_waitcnt lgkmcnt(4)
    v_mfma_f32_16x16x32_bf16 v[68:71], v[48:51], v[16:19], 0
    v_mfma_f32_16x16x32_bf16 v[68:71], v[52:55], v[20:23], v[68:71]
    v_mfma_f32_16x16x32_bf16 v[68:71], v[56:59], v[24:27], v[68:71]
    v_mfma_f32_16x16x32_bf16 v[68:71], v[60:63], v[28:31], v[68:71]
    s_add_u32 s59, s53, 65536
    s_and_b32 s59, s59, 0x1ffff
    buffer_load_dwordx4 v[200:203], v8, s[36:39], s59 offen offset:2048 nt
    s_waitcnt vmcnt(9)
    ds_read_b128 v[48:51], v9 offset:12288
    ds_read_b128 v[52:55], v10 offset:12288
    ds_read_b128 v[56:59], v11 offset:12288
    ds_read_b128 v[60:63], v12 offset:12288
    s_waitcnt lgkmcnt(4)
    v_mfma_f32_16x16x32_bf16 v[72:75], v[32:35], v[16:19], 0
    v_mfma_f32_16x16x32_bf16 v[72:75], v[36:39], v[20:23], v[72:75]
    v_mfma_f32_16x16x32_bf16 v[72:75], v[40:43], v[24:27], v[72:75]
    v_mfma_f32_16x16x32_bf16 v[72:75], v[44:47], v[28:31], v[72:75]
    s_add_u32 s59, s53, 65536
    s_and_b32 s59, s59, 0x1ffff
    buffer_load_dwordx4 v[204:207], v8, s[36:39], s59 offen offset:3072 nt
    s_waitcnt vmcnt(9)
    ds_read_b128 v[32:35], v9 offset:16384
    ds_read_b128 v[36:39], v10 offset:16384
    ds_read_b128 v[40:43], v11 offset:16384
    ds_read_b128 v[44:47], v12 offset:16384
    s_waitcnt lgkmcnt(4)
    v_mfma_f32_16x16x32_bf16 v[76:79], v[48:51], v[16:19], 0
    v_mfma_f32_16x16x32_bf16 v[76:79], v[52:55], v[20:23], v[76:79]
    v_mfma_f32_16x16x32_bf16 v[76:79], v[56:59], v[24:27], v[76:79]
    v_mfma_f32_16x16x32_bf16 v[76:79], v[60:63], v[28:31], v[76:79]
    s_add_u32 s59, s53, 81920
    s_and_b32 s59, s59, 0x1ffff
    buffer_load_dwordx4 v[208:211], v8, s[36:39], s59 offen offset:0 nt
    s_waitcnt vmcnt(9)
    ds_read_b128 v[48:51], v9 offset:20480
    ds_read_b128 v[52:55], v10 offset:20480
    ds_read_b128 v[56:59], v11 offset:20480
    ds_read_b128 v[60:63], v12 offset:20480
    s_waitcnt lgkmcnt(4)
    v_mfma_f32_16x16x32_bf16 v[80:83], v[32:35], v[16:19], 0
    v_mfma_f32_16x16x32_bf16 v[80:83], v[36:39], v[20:23], v[80:83]
    v_mfma_f32_16x16x32_bf16 v[80:83], v[40:43], v[24:27], v[80:83]
    v_mfma_f32_16x16x32_bf16 v[80:83], v[44:47], v[28:31], v[80:83]
    s_add_u32 s59, s53, 81920
    s_and_b32 s59, s59, 0x1ffff
    buffer_load_dwordx4 v[212:215], v8, s[36:39], s59 offen offset:1024 nt
    s_waitcnt vmcnt(9)
    ds_read_b128 v[32:35], v9 offset:24576
    ds_read_b128 v[36:39], v10 offset:24576
    ds_read_b128 v[40:43], v11 offset:24576
    ds_read_b128 v[44:47], v12 offset:24576
    s_waitcnt lgkmcnt(4)
    v_mfma_f32_16x16x32_bf16 v[84:87], v[48:51], v[16:19], 0
    v_mfma_f32_16x16x32_bf16 v[84:87], v[52:55], v[20:23], v[84:87]
    v_mfma_f32_16x16x32_bf16 v[84:87], v[56:59], v[24:27], v[84:87]
    v_mfma_f32_16x16x32_bf16 v[84:87], v[60:63], v[28:31], v[84:87]
    s_add_u32 s59, s53, 81920
    s_and_b32 s59, s59, 0x1ffff
    buffer_load_dwordx4 v[216:219], v8, s[36:39], s59 offen offset:2048 nt
    s_waitcnt vmcnt(9)
    ds_read_b128 v[48:51], v9 offset:28672
    ds_read_b128 v[52:55], v10 offset:28672
    ds_read_b128 v[56:59], v11 offset:28672
    ds_read_b128 v[60:63], v12 offset:28672
    s_waitcnt lgkmcnt(4)
    v_mfma_f32_16x16x32_bf16 v[88:91], v[32:35], v[16:19], 0
    v_mfma_f32_16x16x32_bf16 v[88:91], v[36:39], v[20:23], v[88:91]
    v_mfma_f32_16x16x32_bf16 v[88:91], v[40:43], v[24:27], v[88:91]
    v_mfma_f32_16x16x32_bf16 v[88:91], v[44:47], v[28:31], v[88:91]
    s_add_u32 s59, s53, 81920
    s_and_b32 s59, s59, 0x1ffff
    buffer_load_dwordx4 v[220:223], v8, s[36:39], s59 offen offset:3072 nt
    s_waitcnt vmcnt(9)
    s_waitcnt lgkmcnt(0)
    v_mfma_f32_16x16x32_bf16 v[92:95], v[48:51], v[16:19], 0
    v_mfma_f32_16x16x32_bf16 v[92:95], v[52:55], v[20:23], v[92:95]
    v_mfma_f32_16x16x32_bf16 v[92:95], v[56:59], v[24:27], v[92:95]
    v_mfma_f32_16x16x32_bf16 v[92:95], v[60:63], v[28:31], v[92:95]
    s_nop 7
    v_cvt_pk_bf16_f32 v32, v64, v65
    v_lshlrev_b32 v64, 16, v32
    v_and_b32 v65, s96, v32
    v_mul_f32 v64, s97, v64
    v_mul_f32 v65, s97, v65
    v_cvt_pk_bf16_f32 v32, v64, v65
    v_lshlrev_b32 v64, 16, v32
    v_and_b32 v65, s96, v32
    s_add_u32 s59, s53, 98304
    s_and_b32 s59, s59, 0x1ffff
    buffer_load_dwordx4 v[224:227], v8, s[36:39], s59 offen offset:0 nt
    s_waitcnt vmcnt(9)
    v_cvt_pk_bf16_f32 v33, v66, v67
    v_lshlrev_b32 v66, 16, v33
    v_and_b32 v67, s96, v33
    v_mul_f32 v66, s97, v66
    v_mul_f32 v67, s97, v67
    v_cvt_pk_bf16_f32 v33, v66, v67
    v_lshlrev_b32 v66, 16, v33
    v_and_b32 v67, s96, v33
    v_cvt_pk_bf16_f32 v32, v68, v69
    v_lshlrev_b32 v68, 16, v32
    v_and_b32 v69, s96, v32
    v_mul_f32 v68, s97, v68
    v_mul_f32 v69, s97, v69
    v_cvt_pk_bf16_f32 v32, v68, v69
    v_lshlrev_b32 v68, 16, v32
    v_and_b32 v69, s96, v32
    v_cvt_pk_bf16_f32 v33, v70, v71
    v_lshlrev_b32 v70, 16, v33
    v_and_b32 v71, s96, v33
    v_mul_f32 v70, s97, v70
    v_mul_f32 v71, s97, v71
    v_cvt_pk_bf16_f32 v33, v70, v71
    v_lshlrev_b32 v70, 16, v33
    v_and_b32 v71, s96, v33
    v_cvt_pk_bf16_f32 v32, v72, v73
    v_lshlrev_b32 v72, 16, v32
    v_and_b32 v73, s96, v32
    v_mul_f32 v72, s97, v72
    v_mul_f32 v73, s97, v73
    v_cvt_pk_bf16_f32 v32, v72, v73
    v_lshlrev_b32 v72, 16, v32
    v_and_b32 v73, s96, v32
    s_add_u32 s59, s53, 98304
    s_and_b32 s59, s59, 0x1ffff
    buffer_load_dwordx4 v[228:231], v8, s[36:39], s59 offen offset:1024 nt
    s_waitcnt vmcnt(9)
    v_cvt_pk_bf16_f32 v33, v74, v75
    v_lshlrev_b32 v74, 16, v33
    v_and_b32 v75, s96, v33
    v_mul_f32 v74, s97, v74
    v_mul_f32 v75, s97, v75
    v_cvt_pk_bf16_f32 v33, v74, v75
    v_lshlrev_b32 v74, 16, v33
    v_and_b32 v75, s96, v33
    v_cvt_pk_bf16_f32 v32, v76, v77
    v_lshlrev_b32 v76, 16, v32
    v_and_b32 v77, s96, v32
    v_mul_f32 v76, s97, v76
    v_mul_f32 v77, s97, v77
    v_cvt_pk_bf16_f32 v32, v76, v77
    v_lshlrev_b32 v76, 16, v32
    v_and_b32 v77, s96, v32
    v_cvt_pk_bf16_f32 v33, v78, v79
    v_lshlrev_b32 v78, 16, v33
    v_and_b32 v79, s96, v33
    v_mul_f32 v78, s97, v78
    v_mul_f32 v79, s97, v79
    v_cvt_pk_bf16_f32 v33, v78, v79
    v_lshlrev_b32 v78, 16, v33
    v_and_b32 v79, s96, v33
    v_cvt_pk_bf16_f32 v32, v80, v81
    v_lshlrev_b32 v80, 16, v32
    v_and_b32 v81, s96, v32
    v_mul_f32 v80, s97, v80
    v_mul_f32 v81, s97, v81
    v_cvt_pk_bf16_f32 v32, v80, v81
    v_lshlrev_b32 v80, 16, v32
    v_and_b32 v81, s96, v32
    s_add_u32 s59, s53, 98304
    s_and_b32 s59, s59, 0x1ffff
    buffer_load_dwordx4 v[232:235], v8, s[36:39], s59 offen offset:2048 nt
    s_waitcnt vmcnt(9)
    v_cvt_pk_bf16_f32 v33, v82, v83
    v_lshlrev_b32 v82, 16, v33
    v_and_b32 v83, s96, v33
    v_mul_f32 v82, s97, v82
    v_mul_f32 v83, s97, v83
    v_cvt_pk_bf16_f32 v33, v82, v83
    v_lshlrev_b32 v82, 16, v33
    v_and_b32 v83, s96, v33
    v_cvt_pk_bf16_f32 v32, v84, v85
    v_lshlrev_b32 v84, 16, v32
    v_and_b32 v85, s96, v32
    v_mul_f32 v84, s97, v84
    v_mul_f32 v85, s97, v85
    v_cvt_pk_bf16_f32 v32, v84, v85
    v_lshlrev_b32 v84, 16, v32
    v_and_b32 v85, s96, v32
    v_cvt_pk_bf16_f32 v33, v86, v87
    v_lshlrev_b32 v86, 16, v33
    v_and_b32 v87, s96, v33
    v_mul_f32 v86, s97, v86
    v_mul_f32 v87, s97, v87
    v_cvt_pk_bf16_f32 v33, v86, v87
    v_lshlrev_b32 v86, 16, v33
    v_and_b32 v87, s96, v33
    v_cvt_pk_bf16_f32 v32, v88, v89
    v_lshlrev_b32 v88, 16, v32
    v_and_b32 v89, s96, v32
    v_mul_f32 v88, s97, v88
    v_mul_f32 v89, s97, v89
    v_cvt_pk_bf16_f32 v32, v88, v89
    v_lshlrev_b32 v88, 16, v32
    v_and_b32 v89, s96, v32
    s_add_u32 s59, s53, 98304
    s_and_b32 s59, s59, 0x1ffff
    buffer_load_dwordx4 v[236:239], v8, s[36:39], s59 offen offset:3072 nt
    s_waitcnt vmcnt(9)
    v_cvt_pk_bf16_f32 v33, v90, v91
    v_lshlrev_b32 v90, 16, v33
    v_and_b32 v91, s96, v33
    v_mul_f32 v90, s97, v90
    v_mul_f32 v91, s97, v91
    v_cvt_pk_bf16_f32 v33, v90, v91
    v_lshlrev_b32 v90, 16, v33
    v_and_b32 v91, s96, v33
    v_cvt_pk_bf16_f32 v32, v92, v93
    v_lshlrev_b32 v92, 16, v32
    v_and_b32 v93, s96, v32
    v_mul_f32 v92, s97, v92
    v_mul_f32 v93, s97, v93
    v_cvt_pk_bf16_f32 v32, v92, v93
    v_lshlrev_b32 v92, 16, v32
    v_and_b32 v93, s96, v32
    v_cvt_pk_bf16_f32 v33, v94, v95
    v_lshlrev_b32 v94, 16, v33
    v_and_b32 v95, s96, v33
    v_mul_f32 v94, s97, v94
    v_mul_f32 v95, s97, v95
    v_cvt_pk_bf16_f32 v33, v94, v95
    v_lshlrev_b32 v94, 16, v33
    v_and_b32 v95, s96, v33
    v_max3_f32 v34, v64, v65, v66
    v_max3_f32 v34, v34, v67, v68
    v_max3_f32 v34, v34, v69, v70
    v_max3_f32 v34, v34, v71, v72
    v_max3_f32 v34, v34, v73, v74
    v_max3_f32 v34, v34, v75, v76
    v_max3_f32 v34, v34, v77, v78
    v_max3_f32 v34, v34, v79, v80
    v_max3_f32 v34, v34, v81, v82
    v_max3_f32 v34, v34, v83, v84
    v_max3_f32 v34, v34, v85, v86
    v_max3_f32 v34, v34, v87, v88
    v_max3_f32 v34, v34, v89, v90
    v_max3_f32 v34, v34, v91, v92
    v_max3_f32 v34, v34, v93, v94
    v_max_f32 v34, v34, v95
    v_mov_b32 v35, v34
    s_nop 1
    v_permlane32_swap_b32 v35, v34
    s_nop 1
    v_max_f32 v34, v35, v34
    v_mov_b32 v35, v34
    s_nop 1
    v_permlane16_swap_b32 v35, v34
    s_nop 1
    v_max_f32 v34, v35, v34
    ds_write_b32 v15, v34
    s_waitcnt lgkmcnt(0)
    s_barrier
    ds_read2st64_b32 v[36:37], v14 offset0:0 offset1:1
    ds_read2st64_b32 v[38:39], v14 offset0:2 offset1:3
    s_waitcnt lgkmcnt(0)
    v_max3_f32 v34, v36, v37, v38
    v_max_f32 v34, v34, v39
    v_mul_f32 v35, s98, v34
    s_sub_u32 s62, s27, 23
    s_lshl_b32 s60, s62, 18
    s_lshl_b32 s61, s26, 7
    s_add_u32 s60, s60, s61
    s_lshl_b32 s61, s52, 14
    s_add_u32 s60, s60, s61
    s_add_u32 s60, s60, 196608
    s_cmp_lt_u32 s62, 7
    s_cselect_b32 s62, 1835008, 0
    s_mov_b32 s48, s18
    s_mov_b32 s49, s19
    s_mov_b32 s50, s62
    s_mov_b32 s51, 0x20000
    s_lshl_b32 s61, s52, 11
    s_add_u32 s61, s61, 16384
    v_lshrrev_b32 v3, 3, v0
    v_lshlrev_b32 v3, 10, v3
    v_and_b32 v4, 7, v0
    v_lshl_add_u32 v3, v4, 4, v3
    v_fma_f32 v64, v64, s98, -v35
    v_fma_f32 v65, v65, s98, -v35
    v_exp_f32 v64, v64
    v_exp_f32 v65, v65
    v_fma_f32 v66, v66, s98, -v35
    v_fma_f32 v67, v67, s98, -v35
    v_exp_f32 v66, v66
    v_exp_f32 v67, v67
    v_cvt_pk_bf16_f32 v40, v64, v65
    v_fma_f32 v68, v68, s98, -v35
    v_fma_f32 v69, v69, s98, -v35
    v_exp_f32 v68, v68
    v_exp_f32 v69, v69
    v_cvt_pk_bf16_f32 v41, v66, v67
    s_mov_b32 m0, s61
    s_add_u32 s61, s61, 1024
    buffer_load_dwordx4 v3, s[48:51], s60 offen nt lds
    s_add_u32 s60, s60, 8192
    v_fma_f32 v70, v70, s98, -v35
    v_fma_f32 v71, v71, s98, -v35
    v_exp_f32 v70, v70
    v_exp_f32 v71, v71
    v_cvt_pk_bf16_f32 v42, v68, v69
    v_fma_f32 v72, v72, s98, -v35
    v_fma_f32 v73, v73, s98, -v35
    v_exp_f32 v72, v72
    v_exp_f32 v73, v73
    v_cvt_pk_bf16_f32 v43, v70, v71
    v_fma_f32 v74, v74, s98, -v35
    v_fma_f32 v75, v75, s98, -v35
    v_exp_f32 v74, v74
    v_exp_f32 v75, v75
    v_cvt_pk_bf16_f32 v44, v72, v73
    s_mov_b32 m0, s61
    s_add_u32 s61, s61, 1024
    buffer_load_dwordx4 v3, s[48:51], s60 offen nt lds
    s_add_u32 s60, s60, 8192
    v_fma_f32 v76, v76, s98, -v35
    v_fma_f32 v77, v77, s98, -v35
    v_exp_f32 v76, v76
    v_exp_f32 v77, v77
    v_cvt_pk_bf16_f32 v45, v74, v75
    v_fma_f32 v78, v78, s98, -v35
    v_fma_f32 v79, v79, s98, -v35
    v_exp_f32 v78, v78
    v_exp_f32 v79, v79
    v_cvt_pk_bf16_f32 v46, v76, v77
    v_fma_f32 v80, v80, s98, -v35
    v_fma_f32 v81, v81, s98, -v35
    v_exp_f32 v80, v80
    v_exp_f32 v81, v81
    v_cvt_pk_bf16_f32 v47, v78, v79
    v_fma_f32 v82, v82, s98, -v35
    v_fma_f32 v83, v83, s98, -v35
    v_exp_f32 v82, v82
    v_exp_f32 v83, v83
    v_cvt_pk_bf16_f32 v48, v80, v81
    s_add_u32 s59, s53, 114688
    s_and_b32 s59, s59, 0x1ffff
    buffer_load_dwordx4 v[240:243], v8, s[36:39], s59 offen offset:0 nt
    s_waitcnt vmcnt(9)
    v_fma_f32 v84, v84, s98, -v35
    v_fma_f32 v85, v85, s98, -v35
    v_exp_f32 v84, v84
    v_exp_f32 v85, v85
    v_cvt_pk_bf16_f32 v49, v82, v83
    v_fma_f32 v86, v86, s98, -v35
    v_fma_f32 v87, v87, s98, -v35
    v_exp_f32 v86, v86
    v_exp_f32 v87, v87
    v_cvt_pk_bf16_f32 v50, v84, v85
    s_add_u32 s59, s53, 114688
    s_and_b32 s59, s59, 0x1ffff
    buffer_load_dwordx4 v[244:247], v8, s[36:39], s59 offen offset:1024 nt
    s_waitcnt vmcnt(9)
    v_fma_f32 v88, v88, s98, -v35
    v_fma_f32 v89, v89, s98, -v35
    v_exp_f32 v88, v88
    v_exp_f32 v89, v89
    v_cvt_pk_bf16_f32 v51, v86, v87
    v_fma_f32 v90, v90, s98, -v35
    v_fma_f32 v91, v91, s98, -v35
    v_exp_f32 v90, v90
    v_exp_f32 v91, v91
    v_cvt_pk_bf16_f32 v52, v88, v89
    s_add_u32 s59, s53, 114688
    s_and_b32 s59, s59, 0x1ffff
    buffer_load_dwordx4 v[248:251], v8, s[36:39], s59 offen offset:2048 nt
    s_waitcnt vmcnt(9)
    v_fma_f32 v92, v92, s98, -v35
    v_fma_f32 v93, v93, s98, -v35
    v_exp_f32 v92, v92
    v_exp_f32 v93, v93
    v_cvt_pk_bf16_f32 v53, v90, v91
    v_fma_f32 v94, v94, s98, -v35
    v_fma_f32 v95, v95, s98, -v35
    v_exp_f32 v94, v94
    v_exp_f32 v95, v95
    v_cvt_pk_bf16_f32 v54, v92, v93
    s_add_u32 s59, s53, 114688
    s_and_b32 s59, s59, 0x1ffff
    buffer_load_dwordx4 v[252:255], v8, s[36:39], s59 offen offset:3072 nt
    s_waitcnt vmcnt(9)
    v_mov_b32 v100, 0x3f803f80
    v_mov_b32 v101, 0x3f803f80
    v_mov_b32 v102, 0x3f803f80
    v_mov_b32 v103, 0x3f803f80
    v_cvt_pk_bf16_f32 v55, v94, v95
    s_lshl_b32 s60, s52, 8
    s_add_u32 s60, s60, 8192
    v_lshlrev_b32 v6, 2, v0
    v_add_u32 v5, s60, v6
    v_mfma_f32_16x16x32_bf16 v[96:99], v[40:43], v[100:103], 0
    v_mfma_f32_16x16x32_bf16 v[96:99], v[44:47], v[100:103], v[96:99]
    v_mfma_f32_16x16x32_bf16 v[96:99], v[48:51], v[100:103], v[96:99]
    v_mfma_f32_16x16x32_bf16 v[96:99], v[52:55], v[100:103], v[96:99]
    s_nop 7
    ds_write_b32 v5, v96
    s_waitcnt lgkmcnt(0)
    s_barrier
    s_lshl_b32 s64, s29, 10
    s_lshl_b32 s65, s26, 7
    s_add_u32 s64, s64, s65
    s_lshl_b32 s65, s30, 4
    s_add_u32 s64, s64, s65
    s_load_dwordx4 s[48:51], s[4:5], s64
    s_mov_b32 s40, s24
    s_mov_b32 s41, s25
    s_mov_b32 s42, 1900544
    s_mov_b32 s43, 0x20000
    s_lshl_b32 s60, s26, 2
    s_add_u32 s60, s60, s29
    s_lshl_b32 s60, s60, 17
    s_lshl_b32 s61, s30, 7
    s_add_u32 s60, s60, s61
    s_lshl_b32 s61, s52, 15
    s_add_u32 s60, s60, s61
    s_mov_b32 s44, s12
    s_mov_b32 s45, s13
    s_mov_b32 s46, 4194304
    s_mov_b32 s47, 0x20000
    s_lshl_b32 s61, s52, 12
    s_add_u32 s61, s61, 32768
    s_waitcnt vmcnt(26)
    s_mov_b32 m0, s61
    s_add_u32 s61, s61, 1024
    buffer_load_dwordx4 v3, s[44:47], s60 offen nt lds
    s_add_u32 s60, s60, 8192
    v_perm_b32 v16, v132, v128, s99
    v_perm_b32 v17, v140, v136, s99
    v_perm_b32 v18, v148, v144, s99
    v_perm_b32 v19, v156, v152, s99
    v_perm_b32 v20, v132, v128, s100
    v_perm_b32 v21, v140, v136, s100
    v_perm_b32 v22, v148, v144, s100
    v_perm_b32 v23, v156, v152, s100
    s_mov_b32 m0, s61
    s_add_u32 s61, s61, 1024
    buffer_load_dwordx4 v3, s[44:47], s60 offen nt lds
    s_add_u32 s60, s60, 8192
    v_perm_b32 v24, v133, v129, s99
    v_perm_b32 v25, v141, v137, s99
    v_perm_b32 v26, v149, v145, s99
    v_perm_b32 v27, v157, v153, s99
    v_perm_b32 v28, v133, v129, s100
    v_perm_b32 v29, v141, v137, s100
    v_perm_b32 v30, v149, v145, s100
    v_perm_b32 v31, v157, v153, s100
    v_mfma_f32_16x16x32_bf16 v[64:67], v[40:43], v[16:19], 0
    v_mfma_f32_16x16x32_bf16 v[68:71], v[40:43], v[20:23], 0
    s_mov_b32 m0, s61
    s_add_u32 s61, s61, 1024
    buffer_load_dwordx4 v3, s[44:47], s60 offen nt lds
    s_add_u32 s60, s60, 8192
    v_perm_b32 v16, v134, v130, s99
    v_perm_b32 v17, v142, v138, s99
    v_perm_b32 v18, v150, v146, s99
    v_perm_b32 v19, v158, v154, s99
    v_perm_b32 v20, v134, v130, s100
    v_perm_b32 v21, v142, v138, s100
    v_perm_b32 v22, v150, v146, s100
    v_perm_b32 v23, v158, v154, s100
    v_mfma_f32_16x16x32_bf16 v[72:75], v[40:43], v[24:27], 0
    v_mfma_f32_16x16x32_bf16 v[76:79], v[40:43], v[28:31], 0
    s_mov_b32 m0, s61
    s_add_u32 s61, s61, 1024
    buffer_load_dwordx4 v3, s[44:47], s60 offen nt lds
    s_add_u32 s60, s60, 8192
    v_perm_b32 v24, v135, v131, s99
    v_perm_b32 v25, v143, v139, s99
    v_perm_b32 v26, v151, v147, s99
    v_perm_b32 v27, v159, v155, s99
    v_perm_b32 v28, v135, v131, s100
    v_perm_b32 v29, v143, v139, s100
    v_perm_b32 v30, v151, v147, s100
    v_perm_b32 v31, v159, v155, s100
    v_mfma_f32_16x16x32_bf16 v[80:83], v[40:43], v[16:19], 0
    v_mfma_f32_16x16x32_bf16 v[84:87], v[40:43], v[20:23], 0
    s_nop 1
    v_mfma_f32_16x16x32_bf16 v[88:91], v[40:43], v[24:27], 0
    v_mfma_f32_16x16x32_bf16 v[92:95], v[40:43], v[28:31], 0
    s_waitcnt vmcnt(22)
    v_perm_b32 v16, v164, v160, s99
    v_perm_b32 v17, v172, v168, s99
    v_perm_b32 v18, v180, v176, s99
    v_perm_b32 v19, v188, v184, s99
    v_perm_b32 v20, v164, v160, s100
    v_perm_b32 v21, v172, v168, s100
    v_perm_b32 v22, v180, v176, s100
    v_perm_b32 v23, v188, v184, s100
    v_perm_b32 v24, v165, v161, s99
    v_perm_b32 v25, v173, v169, s99
    v_perm_b32 v26, v181, v177, s99
    v_perm_b32 v27, v189, v185, s99
    v_perm_b32 v28, v165, v161, s100
    v_perm_b32 v29, v173, v169, s100
    v_perm_b32 v30, v181, v177, s100
    v_perm_b32 v31, v189, v185, s100
    v_mfma_f32_16x16x32_bf16 v[64:67], v[44:47], v[16:19], v[64:67]
    v_mfma_f32_16x16x32_bf16 v[68:71], v[44:47], v[20:23], v[68:71]
    v_perm_b32 v16, v166, v162, s99
    v_perm_b32 v17, v174, v170, s99
    v_perm_b32 v18, v182, v178, s99
    v_perm_b32 v19, v190, v186, s99
    v_perm_b32 v20, v166, v162, s100
    v_perm_b32 v21, v174, v170, s100
    v_perm_b32 v22, v182, v178, s100
    v_perm_b32 v23, v190, v186, s100
    v_mfma_f32_16x16x32_bf16 v[72:75], v[44:47], v[24:27], v[72:75]
    v_mfma_f32_16x16x32_bf16 v[76:79], v[44:47], v[28:31], v[76:79]
    v_perm_b32 v24, v167, v163, s99
    v_perm_b32 v25, v175, v171, s99
    v_perm_b32 v26, v183, v179, s99
    v_perm_b32 v27, v191, v187, s99
    v_perm_b32 v28, v167, v163, s100
    v_perm_b32 v29, v175, v171, s100
    v_perm_b32 v30, v183, v179, s100
    v_perm_b32 v31, v191, v187, s100
    v_mfma_f32_16x16x32_bf16 v[80:83], v[44:47], v[16:19], v[80:83]
    v_mfma_f32_16x16x32_bf16 v[84:87], v[44:47], v[20:23], v[84:87]
    s_nop 1
    v_mfma_f32_16x16x32_bf16 v[88:91], v[44:47], v[24:27], v[88:91]
    v_mfma_f32_16x16x32_bf16 v[92:95], v[44:47], v[28:31], v[92:95]
    s_waitcnt vmcnt(8)
    s_barrier
    v_perm_b32 v16, v196, v192, s99
    v_perm_b32 v17, v204, v200, s99
    v_perm_b32 v18, v212, v208, s99
    v_perm_b32 v19, v220, v216, s99
    v_perm_b32 v20, v196, v192, s100
    v_perm_b32 v21, v204, v200, s100
    v_perm_b32 v22, v212, v208, s100
    v_perm_b32 v23, v220, v216, s100
    v_perm_b32 v24, v197, v193, s99
    v_perm_b32 v25, v205, v201, s99
    v_perm_b32 v26, v213, v209, s99
    v_perm_b32 v27, v221, v217, s99
    v_perm_b32 v28, v197, v193, s100
    v_perm_b32 v29, v205, v201, s100
    v_perm_b32 v30, v213, v209, s100
    v_perm_b32 v31, v221, v217, s100
    v_mfma_f32_16x16x32_bf16 v[64:67], v[48:51], v[16:19], v[64:67]
    v_mfma_f32_16x16x32_bf16 v[68:71], v[48:51], v[20:23], v[68:71]
    v_perm_b32 v16, v198, v194, s99
    v_perm_b32 v17, v206, v202, s99
    v_perm_b32 v18, v214, v210, s99
    v_perm_b32 v19, v222, v218, s99
    v_perm_b32 v20, v198, v194, s100
    v_perm_b32 v21, v206, v202, s100
    v_perm_b32 v22, v214, v210, s100
    v_perm_b32 v23, v222, v218, s100
    v_mfma_f32_16x16x32_bf16 v[72:75], v[48:51], v[24:27], v[72:75]
    v_mfma_f32_16x16x32_bf16 v[76:79], v[48:51], v[28:31], v[76:79]
    v_perm_b32 v24, v199, v195, s99
    v_perm_b32 v25, v207, v203, s99
    v_perm_b32 v26, v215, v211, s99
    v_perm_b32 v27, v223, v219, s99
    v_perm_b32 v28, v199, v195, s100
    v_perm_b32 v29, v207, v203, s100
    v_perm_b32 v30, v215, v211, s100
    v_perm_b32 v31, v223, v219, s100
    v_mfma_f32_16x16x32_bf16 v[80:83], v[48:51], v[16:19], v[80:83]
    v_mfma_f32_16x16x32_bf16 v[84:87], v[48:51], v[20:23], v[84:87]
    s_nop 1
    v_mfma_f32_16x16x32_bf16 v[88:91], v[48:51], v[24:27], v[88:91]
    v_mfma_f32_16x16x32_bf16 v[92:95], v[48:51], v[28:31], v[92:95]
    s_lshl_b32 s60, s52, 11
    v_lshlrev_b32 v3, 5, v0
    v_add_u32 v4, s60, v3
    s_lshl_b32 s67, s26, 12
    s_lshr_b32 s68, s28, 1
    s_lshl_b32 s68, s68, 10
    s_add_u32 s67, s67, s68
    s_lshl_b32 s68, s29, 3
    s_add_u32 s67, s67, s68
    s_add_u32 s67, s67, 4096
    v_lshlrev_b32 v104, 7, v1
    s_lshl_b32 s14, s26, 16
    s_lshl_b32 s15, s29, 14
    s_add_u32 s14, s14, s15
    s_lshl_b32 s15, s28, 8
    s_add_u32 s14, s14, s15
    s_add_u32 s14, s14, 851968
    s_add_u32 s15, s14, 8192
    v_lshlrev_b32 v105, 11, v1
    v_lshl_add_u32 v105, v2, 4, v105
    s_lshl_b32 s61, s28, 7
    s_add_u32 s61, s61, 10240
    v_lshlrev_b32 v112, 3, v2
    v_lshl_add_u32 v112, v1, 1, v112
    v_add_u32 v112, s61, v112
    s_waitcnt vmcnt(4)
    v_perm_b32 v16, v228, v224, s99
    v_perm_b32 v17, v236, v232, s99
    v_perm_b32 v18, v244, v240, s99
    v_perm_b32 v19, v252, v248, s99
    v_perm_b32 v20, v228, v224, s100
    v_perm_b32 v21, v236, v232, s100
    v_perm_b32 v22, v244, v240, s100
    v_perm_b32 v23, v252, v248, s100
    v_perm_b32 v24, v229, v225, s99
    v_perm_b32 v25, v237, v233, s99
    v_perm_b32 v26, v245, v241, s99
    v_perm_b32 v27, v253, v249, s99
    v_perm_b32 v28, v229, v225, s100
    v_perm_b32 v29, v237, v233, s100
    v_perm_b32 v30, v245, v241, s100
    v_perm_b32 v31, v253, v249, s100
    v_mfma_f32_16x16x32_bf16 v[64:67], v[52:55], v[16:19], v[64:67]
    v_mfma_f32_16x16x32_bf16 v[68:71], v[52:55], v[20:23], v[68:71]
    v_perm_b32 v16, v230, v226, s99
    v_perm_b32 v17, v238, v234, s99
    v_perm_b32 v18, v246, v242, s99
    v_perm_b32 v19, v254, v250, s99
    v_perm_b32 v20, v230, v226, s100
    v_perm_b32 v21, v238, v234, s100
    v_perm_b32 v22, v246, v242, s100
    v_perm_b32 v23, v254, v250, s100
    v_mfma_f32_16x16x32_bf16 v[72:75], v[52:55], v[24:27], v[72:75]
    v_mfma_f32_16x16x32_bf16 v[76:79], v[52:55], v[28:31], v[76:79]
    v_perm_b32 v24, v231, v227, s99
    v_perm_b32 v25, v239, v235, s99
    v_perm_b32 v26, v247, v243, s99
    v_perm_b32 v27, v255, v251, s99
    v_perm_b32 v28, v231, v227, s100
    v_perm_b32 v29, v239, v235, s100
    v_perm_b32 v30, v247, v243, s100
    v_perm_b32 v31, v255, v251, s100
    v_mfma_f32_16x16x32_bf16 v[80:83], v[52:55], v[16:19], v[80:83]
    v_mfma_f32_16x16x32_bf16 v[84:87], v[52:55], v[20:23], v[84:87]
    s_nop 1
    v_mfma_f32_16x16x32_bf16 v[88:91], v[52:55], v[24:27], v[88:91]
    v_mfma_f32_16x16x32_bf16 v[92:95], v[52:55], v[28:31], v[92:95]
    s_nop 1
    v_mov_b32 v16, v64
    v_mov_b32 v17, v68
    v_mov_b32 v18, v72
    v_mov_b32 v19, v76
    v_mov_b32 v20, v80
    v_mov_b32 v21, v84
    v_mov_b32 v22, v88
    v_mov_b32 v23, v92
    ds_write_b128 v4, v[16:19]
    ds_write_b128 v4, v[20:23] offset:16
    s_waitcnt lgkmcnt(0)
    s_barrier
    s_branch L_wts2
L_H:
    s_setprio 3
    s_mov_b32 s96, 0xffff0000
    v_mov_b32 v9, 0
    s_sub_u32 s70, s27, 16
    s_lshl_b32 s70, s70, 3
    s_add_u32 s70, s70, s26
    s_cmp_lt_u32 s27, 16
    s_cselect_b32 s71, s29, s70
    s_and_b32 s71, s71, 1
    s_lshr_b32 s70, s70, 1
    s_and_b32 s68, s27, 1
    s_cmp_ge_u32 s27, 30
    s_cselect_b32 s71, s68, s71
    s_cselect_b32 s68, 3, 0
    s_and_b32 s3, s27, 0x17
    s_cmp_eq_u32 s3, 3
    s_cselect_b32 s3, 1, s68
    v_mov_b32 v3, 0
    s_cmp_lg_u32 s28, 0
    s_cbranch_scc1 L_H23
    s_sub_u32 s52, s27, 23
    s_cmp_lt_u32 s52, 7
    s_cbranch_scc1 L_H23
    s_lshl_b32 s57, s71, 1
    s_lshr_b32 s52, s3, 1
    s_add_u32 s57, s57, s52
    s_lshl_b32 s60, s26, 14
    s_lshl_b32 s52, s27, 10
    s_add_u32 s60, s60, s52
    s_add_u32 s60, s60, 65536
    s_lshl_b32 s52, s70, 1
    s_add_u32 s52, s52, s71
    s_lshl_b32 s52, s52, 10
    s_add_u32 s52, s52, 589824
    s_cmp_lt_u32 s27, 16
    s_cselect_b32 s60, s60, s52
    s_lshl_b32 s52, s26, 1
    s_add_u32 s52, s52, s71
    s_lshl_b32 s52, s52, 10
    s_add_u32 s52, s52, 196608
    s_cmp_eq_u32 s3, 3
    s_cselect_b32 s60, s52, s60
    v_and_b32 v3, 3, v2
    v_lshrrev_b32 v10, 2, v2
    v_lshlrev_b32 v4, 10, v3
    v_lshl_add_u32 v4, v10, 8, v4
    v_lshl_add_u32 v4, v1, 4, v4
    s_waitcnt lgkmcnt(0)
    s_mov_b32 s36, s4
    s_mov_b32 s37, s5
    s_mov_b32 s38, 4096
    s_mov_b32 s39, 0x20000
    buffer_load_dwordx4 v[16:19], v4, s[36:39], 0 offen offset:0
    buffer_load_dwordx4 v[20:23], v4, s[36:39], 0 offen offset:64
    buffer_load_dwordx4 v[24:27], v4, s[36:39], 0 offen offset:128
    buffer_load_dwordx4 v[28:31], v4, s[36:39], 0 offen offset:192
    s_load_dwordx4 s[20:23], s[0:1], 64
    s_load_dwordx2 s[24:25], s[0:1], 80
    v_lshlrev_b32 v14, 10, v1
    v_lshl_add_u32 v14, v10, 7, v14
    v_lshl_add_u32 v14, v3, 3, v14
    v_add_u32 v14, 131072, v14
    v_subrev_u32 v11, s57, v10
    v_and_b32 v11, 3, v11
    v_lshlrev_b32 v5, 8, v3
    v_lshl_add_u32 v5, v11, 6, v5
    v_lshl_add_u32 v5, v1, 4, v5
    v_cmp_ne_u32 s[64:65], 1, v11
    v_cmp_ne_u32 s[66:67], 2, v11
    v_cmp_ne_u32 s[68:69], 3, v11
    s_waitcnt lgkmcnt(0)
    s_load_dword s31, s[24:25], 0
    s_mov_b32 s40, s24
    s_mov_b32 s41, s25
    s_mov_b32 s42, 1900544
    s_mov_b32 s43, 0x20000
    s_waitcnt vmcnt(0)
    v_lshlrev_b32 v32, 16, v16
    v_and_b32 v33, s96, v16
    v_lshlrev_b32 v34, 16, v17
    v_and_b32 v35, s96, v17
    v_lshlrev_b32 v36, 16, v18
    v_and_b32 v37, s96, v18
    v_lshlrev_b32 v38, 16, v19
    v_and_b32 v39, s96, v19
    v_lshlrev_b32 v40, 16, v20
    v_and_b32 v41, s96, v20
    v_lshlrev_b32 v42, 16, v21
    v_and_b32 v43, s96, v21
    v_lshlrev_b32 v44, 16, v22
    v_and_b32 v45, s96, v22
    v_lshlrev_b32 v46, 16, v23
    v_and_b32 v47, s96, v23
    v_lshlrev_b32 v48, 16, v24
    v_and_b32 v49, s96, v24
    v_lshlrev_b32 v50, 16, v25
    v_and_b32 v51, s96, v25
    v_lshlrev_b32 v52, 16, v26
    v_and_b32 v53, s96, v26
    v_lshlrev_b32 v54, 16, v27
    v_and_b32 v55, s96, v27
    v_lshlrev_b32 v56, 16, v28
    v_and_b32 v57, s96, v28
    v_lshlrev_b32 v58, 16, v29
    v_and_b32 v59, s96, v29
    v_lshlrev_b32 v60, 16, v30
    v_and_b32 v61, s96, v30
    v_lshlrev_b32 v62, 16, v31
    v_and_b32 v63, s96, v31
    v_add_f32 v7, v32, v33
    v_add_f32 v8, v34, v35
    v_add_f32 v7, v7, v36
    v_add_f32 v8, v8, v37
    v_add_f32 v7, v7, v38
    v_add_f32 v8, v8, v39
    v_add_f32 v7, v7, v40
    v_add_f32 v8, v8, v41
    v_add_f32 v7, v7, v42
    v_add_f32 v8, v8, v43
    v_add_f32 v7, v7, v44
    v_add_f32 v8, v8, v45
    v_add_f32 v7, v7, v46
    v_add_f32 v8, v8, v47
    v_add_f32 v7, v7, v48
    v_add_f32 v8, v8, v49
    v_add_f32 v7, v7, v50
    v_add_f32 v8, v8, v51
    v_add_f32 v7, v7, v52
    v_add_f32 v8, v8, v53
    v_add_f32 v7, v7, v54
    v_add_f32 v8, v8, v55
    v_add_f32 v7, v7, v56
    v_add_f32 v8, v8, v57
    v_add_f32 v7, v7, v58
    v_add_f32 v8, v8, v59
    v_add_f32 v7, v7, v60
    v_add_f32 v8, v8, v61
    v_add_f32 v7, v7, v62
    v_add_f32 v8, v8, v63
    v_add_f32 v7, v7, v8
    s_nop 1
    v_add_f32_dpp v7, v7, v7 row_ror:4 row_mask:0xf bank_mask:0xf
    s_nop 1
    v_add_f32_dpp v7, v7, v7 row_ror:8 row_mask:0xf bank_mask:0xf
    v_mov_b32 v9, v7
    s_nop 1
    v_permlane32_swap_b32 v9, v7
    s_nop 1
    v_add_f32 v7, v9, v7
    v_mov_b32 v9, v7
    s_nop 1
    v_permlane16_swap_b32 v9, v7
    s_nop 1
    v_add_f32 v7, v9, v7
    v_mul_f32 v7, 0x3b000000, v7
    v_sub_f32 v12, v32, v7
    v_sub_f32 v6, v33, v7
    v_mul_f32 v8, v12, v12
    v_mul_f32 v13, v6, v6
    v_sub_f32 v12, v34, v7
    v_sub_f32 v6, v35, v7
    v_fmac_f32 v8, v12, v12
    v_fmac_f32 v13, v6, v6
    v_sub_f32 v12, v36, v7
    v_sub_f32 v6, v37, v7
    v_fmac_f32 v8, v12, v12
    v_fmac_f32 v13, v6, v6
    v_sub_f32 v12, v38, v7
    v_sub_f32 v6, v39, v7
    v_fmac_f32 v8, v12, v12
    v_fmac_f32 v13, v6, v6
    v_sub_f32 v12, v40, v7
    v_sub_f32 v6, v41, v7
    v_fmac_f32 v8, v12, v12
    v_fmac_f32 v13, v6, v6
    v_sub_f32 v12, v42, v7
    v_sub_f32 v6, v43, v7
    v_fmac_f32 v8, v12, v12
    v_fmac_f32 v13, v6, v6
    v_sub_f32 v12, v44, v7
    v_sub_f32 v6, v45, v7
    v_fmac_f32 v8, v12, v12
    v_fmac_f32 v13, v6, v6
    v_sub_f32 v12, v46, v7
    v_sub_f32 v6, v47, v7
    v_fmac_f32 v8, v12, v12
    v_fmac_f32 v13, v6, v6
    v_sub_f32 v12, v48, v7
    v_sub_f32 v6, v49, v7
    v_fmac_f32 v8, v12, v12
    v_fmac_f32 v13, v6, v6
    v_sub_f32 v12, v50, v7
    v_sub_f32 v6, v51, v7
    v_fmac_f32 v8, v12, v12
    v_fmac_f32 v13, v6, v6
    v_sub_f32 v12, v52, v7
    v_sub_f32 v6, v53, v7
    v_fmac_f32 v8, v12, v12
    v_fmac_f32 v13, v6, v6
    v_sub_f32 v12, v54, v7
    v_sub_f32 v6, v55, v7
    v_fmac_f32 v8, v12, v12
    v_fmac_f32 v13, v6, v6
    v_sub_f32 v12, v56, v7
    v_sub_f32 v6, v57, v7
    v_fmac_f32 v8, v12, v12
    v_fmac_f32 v13, v6, v6
    v_sub_f32 v12, v58, v7
    v_sub_f32 v6, v59, v7
    v_fmac_f32 v8, v12, v12
    v_fmac_f32 v13, v6, v6
    v_sub_f32 v12, v60, v7
    v_sub_f32 v6, v61, v7
    v_fmac_f32 v8, v12, v12
    v_fmac_f32 v13, v6, v6
    v_sub_f32 v12, v62, v7
    v_sub_f32 v6, v63, v7
    v_fmac_f32 v8, v12, v12
    v_fmac_f32 v13, v6, v6
    v_add_f32 v8, v8, v13
    s_nop 1
    v_add_f32_dpp v8, v8, v8 row_ror:4 row_mask:0xf bank_mask:0xf
    s_nop 1
    v_add_f32_dpp v8, v8, v8 row_ror:8 row_mask:0xf bank_mask:0xf
    v_mov_b32 v9, v8
    s_nop 1
    v_permlane32_swap_b32 v9, v8
    s_nop 1
    v_add_f32 v8, v9, v8
    v_mov_b32 v9, v8
    s_nop 1
    v_permlane16_swap_b32 v9, v8
    s_nop 1
    v_add_f32 v8, v9, v8
    v_mul_f32 v8, 0x3b000000, v8
    v_cvt_pk_bf16_f32 v9, v7, v8
    v_lshlrev_b32 v7, 16, v9
    v_and_b32 v8, s96, v9
    v_add_f32 v8, 0x3727c5ac, v8
    v_cvt_pk_bf16_f32 v9, v8, v8
    v_and_b32 v8, s96, v9
    v_sqrt_f32 v8, v8
    s_nop 0
    v_cvt_pk_bf16_f32 v9, v8, v8
    v_and_b32 v8, s96, v9
    v_rcp_f32 v8, v8
    v_sub_f32 v32, v32, v7
    v_sub_f32 v33, v33, v7
    v_cvt_pk_bf16_f32 v9, v32, v33
    v_lshlrev_b32 v32, 16, v9
    v_and_b32 v33, s96, v9
    v_mul_f32 v32, v32, v8
    v_mul_f32 v33, v33, v8
    v_cvt_pk_bf16_f32 v16, v32, v33
    v_sub_f32 v34, v34, v7
    v_sub_f32 v35, v35, v7
    v_cvt_pk_bf16_f32 v9, v34, v35
    v_lshlrev_b32 v34, 16, v9
    v_and_b32 v35, s96, v9
    v_mul_f32 v34, v34, v8
    v_mul_f32 v35, v35, v8
    v_cvt_pk_bf16_f32 v17, v34, v35
    v_sub_f32 v36, v36, v7
    v_sub_f32 v37, v37, v7
    v_cvt_pk_bf16_f32 v9, v36, v37
    v_lshlrev_b32 v36, 16, v9
    v_and_b32 v37, s96, v9
    v_mul_f32 v36, v36, v8
    v_mul_f32 v37, v37, v8
    v_cvt_pk_bf16_f32 v18, v36, v37
    v_sub_f32 v38, v38, v7
    v_sub_f32 v39, v39, v7
    v_cvt_pk_bf16_f32 v9, v38, v39
    v_lshlrev_b32 v38, 16, v9
    v_and_b32 v39, s96, v9
    v_mul_f32 v38, v38, v8
    v_mul_f32 v39, v39, v8
    v_cvt_pk_bf16_f32 v19, v38, v39
    v_sub_f32 v40, v40, v7
    v_sub_f32 v41, v41, v7
    v_cvt_pk_bf16_f32 v9, v40, v41
    v_lshlrev_b32 v40, 16, v9
    v_and_b32 v41, s96, v9
    v_mul_f32 v40, v40, v8
    v_mul_f32 v41, v41, v8
    v_cvt_pk_bf16_f32 v20, v40, v41
    v_sub_f32 v42, v42, v7
    v_sub_f32 v43, v43, v7
    v_cvt_pk_bf16_f32 v9, v42, v43
    v_lshlrev_b32 v42, 16, v9
    v_and_b32 v43, s96, v9
    v_mul_f32 v42, v42, v8
    v_mul_f32 v43, v43, v8
    v_cvt_pk_bf16_f32 v21, v42, v43
    v_sub_f32 v44, v44, v7
    v_sub_f32 v45, v45, v7
    v_cvt_pk_bf16_f32 v9, v44, v45
    v_lshlrev_b32 v44, 16, v9
    v_and_b32 v45, s96, v9
    v_mul_f32 v44, v44, v8
    v_mul_f32 v45, v45, v8
    v_cvt_pk_bf16_f32 v22, v44, v45
    v_sub_f32 v46, v46, v7
    v_sub_f32 v47, v47, v7
    v_cvt_pk_bf16_f32 v9, v46, v47
    v_lshlrev_b32 v46, 16, v9
    v_and_b32 v47, s96, v9
    v_mul_f32 v46, v46, v8
    v_mul_f32 v47, v47, v8
    v_cvt_pk_bf16_f32 v23, v46, v47
    v_sub_f32 v48, v48, v7
    v_sub_f32 v49, v49, v7
    v_cvt_pk_bf16_f32 v9, v48, v49
    v_lshlrev_b32 v48, 16, v9
    v_and_b32 v49, s96, v9
    v_mul_f32 v48, v48, v8
    v_mul_f32 v49, v49, v8
    v_cvt_pk_bf16_f32 v24, v48, v49
    v_sub_f32 v50, v50, v7
    v_sub_f32 v51, v51, v7
    v_cvt_pk_bf16_f32 v9, v50, v51
    v_lshlrev_b32 v50, 16, v9
    v_and_b32 v51, s96, v9
    v_mul_f32 v50, v50, v8
    v_mul_f32 v51, v51, v8
    v_cvt_pk_bf16_f32 v25, v50, v51
    v_sub_f32 v52, v52, v7
    v_sub_f32 v53, v53, v7
    v_cvt_pk_bf16_f32 v9, v52, v53
    v_lshlrev_b32 v52, 16, v9
    v_and_b32 v53, s96, v9
    v_mul_f32 v52, v52, v8
    v_mul_f32 v53, v53, v8
    v_cvt_pk_bf16_f32 v26, v52, v53
    v_sub_f32 v54, v54, v7
    v_sub_f32 v55, v55, v7
    v_cvt_pk_bf16_f32 v9, v54, v55
    v_lshlrev_b32 v54, 16, v9
    v_and_b32 v55, s96, v9
    v_mul_f32 v54, v54, v8
    v_mul_f32 v55, v55, v8
    v_cvt_pk_bf16_f32 v27, v54, v55
    v_sub_f32 v56, v56, v7
    v_sub_f32 v57, v57, v7
    v_cvt_pk_bf16_f32 v9, v56, v57
    v_lshlrev_b32 v56, 16, v9
    v_and_b32 v57, s96, v9
    v_mul_f32 v56, v56, v8
    v_mul_f32 v57, v57, v8
    v_cvt_pk_bf16_f32 v28, v56, v57
    v_sub_f32 v58, v58, v7
    v_sub_f32 v59, v59, v7
    v_cvt_pk_bf16_f32 v9, v58, v59
    v_lshlrev_b32 v58, 16, v9
    v_and_b32 v59, s96, v9
    v_mul_f32 v58, v58, v8
    v_mul_f32 v59, v59, v8
    v_cvt_pk_bf16_f32 v29, v58, v59
    v_sub_f32 v60, v60, v7
    v_sub_f32 v61, v61, v7
    v_cvt_pk_bf16_f32 v9, v60, v61
    v_lshlrev_b32 v60, 16, v9
    v_and_b32 v61, s96, v9
    v_mul_f32 v60, v60, v8
    v_mul_f32 v61, v61, v8
    v_cvt_pk_bf16_f32 v30, v60, v61
    v_sub_f32 v62, v62, v7
    v_sub_f32 v63, v63, v7
    v_cvt_pk_bf16_f32 v9, v62, v63
    v_lshlrev_b32 v62, 16, v9
    v_and_b32 v63, s96, v9
    v_mul_f32 v62, v62, v8
    v_mul_f32 v63, v63, v8
    v_cvt_pk_bf16_f32 v31, v62, v63
    s_waitcnt lgkmcnt(0)
    s_add_u32 s31, s31, 0x9e3779b9
    s_barrier
    ds_read_b64_tr_b16 v[64:65], v14 offset:0
    ds_read_b64_tr_b16 v[66:67], v14 offset:512
    ds_read_b64_tr_b16 v[68:69], v14 offset:4096
    ds_read_b64_tr_b16 v[70:71], v14 offset:4608
    ds_read_b64_tr_b16 v[72:73], v14 offset:8192
    ds_read_b64_tr_b16 v[74:75], v14 offset:8704
    ds_read_b64_tr_b16 v[76:77], v14 offset:12288
    ds_read_b64_tr_b16 v[78:79], v14 offset:12800
    ds_read_b64_tr_b16 v[80:81], v14 offset:16384
    ds_read_b64_tr_b16 v[82:83], v14 offset:16896
    ds_read_b64_tr_b16 v[84:85], v14 offset:20480
    ds_read_b64_tr_b16 v[86:87], v14 offset:20992
    ds_read_b64_tr_b16 v[88:89], v14 offset:24576
    ds_read_b64_tr_b16 v[90:91], v14 offset:25088
    ds_read_b64_tr_b16 v[92:93], v14 offset:28672
    ds_read_b64_tr_b16 v[94:95], v14 offset:29184
    s_waitcnt lgkmcnt(8)
    v_mfma_f32_16x16x32_bf16 v[96:99], v[64:67], v[16:19], 0
    v_mfma_f32_16x16x32_bf16 v[96:99], v[68:71], v[20:23], v[96:99]
    v_mfma_f32_16x16x32_bf16 v[96:99], v[72:75], v[24:27], v[96:99]
    v_mfma_f32_16x16x32_bf16 v[96:99], v[76:79], v[28:31], v[96:99]
    ds_read_b64_tr_b16 v[64:65], v14 offset:32
    ds_read_b64_tr_b16 v[66:67], v14 offset:544
    ds_read_b64_tr_b16 v[68:69], v14 offset:4128
    ds_read_b64_tr_b16 v[70:71], v14 offset:4640
    ds_read_b64_tr_b16 v[72:73], v14 offset:8224
    ds_read_b64_tr_b16 v[74:75], v14 offset:8736
    ds_read_b64_tr_b16 v[76:77], v14 offset:12320
    ds_read_b64_tr_b16 v[78:79], v14 offset:12832
    s_waitcnt lgkmcnt(8)
    v_mfma_f32_16x16x32_bf16 v[112:115], v[80:83], v[16:19], 0
    v_mfma_f32_16x16x32_bf16 v[112:115], v[84:87], v[20:23], v[112:115]
    v_mfma_f32_16x16x32_bf16 v[112:115], v[88:91], v[24:27], v[112:115]
    v_mfma_f32_16x16x32_bf16 v[112:115], v[92:95], v[28:31], v[112:115]
    ds_read_b64_tr_b16 v[80:81], v14 offset:16416
    ds_read_b64_tr_b16 v[82:83], v14 offset:16928
    ds_read_b64_tr_b16 v[84:85], v14 offset:20512
    ds_read_b64_tr_b16 v[86:87], v14 offset:21024
    ds_read_b64_tr_b16 v[88:89], v14 offset:24608
    ds_read_b64_tr_b16 v[90:91], v14 offset:25120
    ds_read_b64_tr_b16 v[92:93], v14 offset:28704
    ds_read_b64_tr_b16 v[94:95], v14 offset:29216
    s_waitcnt lgkmcnt(8)
    v_mfma_f32_16x16x32_bf16 v[100:103], v[64:67], v[16:19], 0
    v_mfma_f32_16x16x32_bf16 v[100:103], v[68:71], v[20:23], v[100:103]
    v_mfma_f32_16x16x32_bf16 v[100:103], v[72:75], v[24:27], v[100:103]
    v_mfma_f32_16x16x32_bf16 v[100:103], v[76:79], v[28:31], v[100:103]
    ds_read_b64_tr_b16 v[64:65], v14 offset:64
    ds_read_b64_tr_b16 v[66:67], v14 offset:576
    ds_read_b64_tr_b16 v[68:69], v14 offset:4160
    ds_read_b64_tr_b16 v[70:71], v14 offset:4672
    ds_read_b64_tr_b16 v[72:73], v14 offset:8256
    ds_read_b64_tr_b16 v[74:75], v14 offset:8768
    ds_read_b64_tr_b16 v[76:77], v14 offset:12352
    ds_read_b64_tr_b16 v[78:79], v14 offset:12864
    s_waitcnt lgkmcnt(8)
    v_mfma_f32_16x16x32_bf16 v[116:119], v[80:83], v[16:19], 0
    v_mfma_f32_16x16x32_bf16 v[116:119], v[84:87], v[20:23], v[116:119]
    v_mfma_f32_16x16x32_bf16 v[116:119], v[88:91], v[24:27], v[116:119]
    v_mfma_f32_16x16x32_bf16 v[116:119], v[92:95], v[28:31], v[116:119]
    ds_read_b64_tr_b16 v[80:81], v14 offset:16448
    ds_read_b64_tr_b16 v[82:83], v14 offset:16960
    ds_read_b64_tr_b16 v[84:85], v14 offset:20544
    ds_read_b64_tr_b16 v[86:87], v14 offset:21056
    ds_read_b64_tr_b16 v[88:89], v14 offset:24640
    ds_read_b64_tr_b16 v[90:91], v14 offset:25152
    ds_read_b64_tr_b16 v[92:93], v14 offset:28736
    ds_read_b64_tr_b16 v[94:95], v14 offset:29248
    s_waitcnt lgkmcnt(8)
    v_mfma_f32_16x16x32_bf16 v[104:107], v[64:67], v[16:19], 0
    v_mfma_f32_16x16x32_bf16 v[104:107], v[68:71], v[20:23], v[104:107]
    v_mfma_f32_16x16x32_bf16 v[104:107], v[72:75], v[24:27], v[104:107]
    v_mfma_f32_16x16x32_bf16 v[104:107], v[76:79], v[28:31], v[104:107]
    ds_read_b64_tr_b16 v[64:65], v14 offset:96
    ds_read_b64_tr_b16 v[66:67], v14 offset:608
    ds_read_b64_tr_b16 v[68:69], v14 offset:4192
    ds_read_b64_tr_b16 v[70:71], v14 offset:4704
    ds_read_b64_tr_b16 v[72:73], v14 offset:8288
    ds_read_b64_tr_b16 v[74:75], v14 offset:8800
    ds_read_b64_tr_b16 v[76:77], v14 offset:12384
    ds_read_b64_tr_b16 v[78:79], v14 offset:12896
    s_waitcnt lgkmcnt(8)
    v_mfma_f32_16x16x32_bf16 v[120:123], v[80:83], v[16:19], 0
    v_mfma_f32_16x16x32_bf16 v[120:123], v[84:87], v[20:23], v[120:123]
    v_mfma_f32_16x16x32_bf16 v[120:123], v[88:91], v[24:27], v[120:123]
    v_mfma_f32_16x16x32_bf16 v[120:123], v[92:95], v[28:31], v[120:123]
    ds_read_b64_tr_b16 v[80:81], v14 offset:16480
    ds_read_b64_tr_b16 v[82:83], v14 offset:16992
    ds_read_b64_tr_b16 v[84:85], v14 offset:20576
    ds_read_b64_tr_b16 v[86:87], v14 offset:21088
    ds_read_b64_tr_b16 v[88:89], v14 offset:24672
    ds_read_b64_tr_b16 v[90:91], v14 offset:25184
    ds_read_b64_tr_b16 v[92:93], v14 offset:28768
    ds_read_b64_tr_b16 v[94:95], v14 offset:29280
    s_waitcnt lgkmcnt(8)
    v_mfma_f32_16x16x32_bf16 v[108:111], v[64:67], v[16:19], 0
    v_mfma_f32_16x16x32_bf16 v[108:111], v[68:71], v[20:23], v[108:111]
    v_mfma_f32_16x16x32_bf16 v[108:111], v[72:75], v[24:27], v[108:111]
    v_mfma_f32_16x16x32_bf16 v[108:111], v[76:79], v[28:31], v[108:111]
    s_waitcnt lgkmcnt(0)
    v_mfma_f32_16x16x32_bf16 v[124:127], v[80:83], v[16:19], 0
    v_mfma_f32_16x16x32_bf16 v[124:127], v[84:87], v[20:23], v[124:127]
    v_mfma_f32_16x16x32_bf16 v[124:127], v[88:91], v[24:27], v[124:127]
    v_mfma_f32_16x16x32_bf16 v[124:127], v[92:95], v[28:31], v[124:127]
    s_mov_b32 s52, 0x07060503
    s_mov_b32 s53, 0x07060502
    s_mov_b32 s54, 0x07060501
    s_nop 4
    v_add_f32_dpp v96, v112, v96 row_ror:12 row_mask:0xf bank_mask:0xf
    v_add_f32_dpp v97, v113, v97 row_ror:12 row_mask:0xf bank_mask:0xf
    v_add_f32_dpp v98, v114, v98 row_ror:12 row_mask:0xf bank_mask:0xf
    v_add_f32_dpp v99, v115, v99 row_ror:12 row_mask:0xf bank_mask:0xf
    v_add_f32_dpp v100, v116, v100 row_ror:12 row_mask:0xf bank_mask:0xf
    v_add_f32_dpp v101, v117, v101 row_ror:12 row_mask:0xf bank_mask:0xf
    v_add_f32_dpp v102, v118, v102 row_ror:12 row_mask:0xf bank_mask:0xf
    v_add_f32_dpp v103, v119, v103 row_ror:12 row_mask:0xf bank_mask:0xf
    v_add_f32_dpp v104, v120, v104 row_ror:12 row_mask:0xf bank_mask:0xf
    v_add_f32_dpp v105, v121, v105 row_ror:12 row_mask:0xf bank_mask:0xf
    v_add_f32_dpp v106, v122, v106 row_ror:12 row_mask:0xf bank_mask:0xf
    v_add_f32_dpp v107, v123, v107 row_ror:12 row_mask:0xf bank_mask:0xf
    v_add_f32_dpp v108, v124, v108 row_ror:12 row_mask:0xf bank_mask:0xf
    v_add_f32_dpp v109, v125, v109 row_ror:12 row_mask:0xf bank_mask:0xf
    v_add_f32_dpp v110, v126, v110 row_ror:12 row_mask:0xf bank_mask:0xf
    v_add_f32_dpp v111, v127, v111 row_ror:12 row_mask:0xf bank_mask:0xf
    s_mov_b64 vcc, s[64:65]
    v_cndmask_b32_dpp v96, v100, v96, vcc row_ror:4 row_mask:0xf bank_mask:0xf
    v_cndmask_b32_dpp v97, v101, v97, vcc row_ror:4 row_mask:0xf bank_mask:0xf
    v_cndmask_b32_dpp v98, v102, v98, vcc row_ror:4 row_mask:0xf bank_mask:0xf
    v_cndmask_b32_dpp v99, v103, v99, vcc row_ror:4 row_mask:0xf bank_mask:0xf
    s_mov_b64 vcc, s[66:67]
    v_cndmask_b32_dpp v96, v104, v96, vcc row_ror:8 row_mask:0xf bank_mask:0xf
    v_cndmask_b32_dpp v97, v105, v97, vcc row_ror:8 row_mask:0xf bank_mask:0xf
    v_cndmask_b32_dpp v98, v106, v98, vcc row_ror:8 row_mask:0xf bank_mask:0xf
    v_cndmask_b32_dpp v99, v107, v99, vcc row_ror:8 row_mask:0xf bank_mask:0xf
    s_mov_b64 vcc, s[68:69]
    v_cndmask_b32_dpp v96, v108, v96, vcc row_ror:12 row_mask:0xf bank_mask:0xf
    v_cndmask_b32_dpp v97, v109, v97, vcc row_ror:12 row_mask:0xf bank_mask:0xf
    v_cndmask_b32_dpp v98, v110, v98, vcc row_ror:12 row_mask:0xf bank_mask:0xf
    v_cndmask_b32_dpp v99, v111, v99, vcc row_ror:12 row_mask:0xf bank_mask:0xf
    v_add_u32 v96, 0x80, v96
    v_add_u32 v97, 0x80, v97
    v_add_u32 v98, 0x80, v98
    v_add_u32 v99, 0x80, v99
    v_perm_b32 v112, v96, v99, s52
    v_perm_b32 v113, v97, v99, s53
    v_perm_b32 v114, v98, v99, s54
    v_xor_b32 v115, v112, v113
    v_xor_b32 v115, v115, v114
    v_xor_b32 v115, s31, v115
    buffer_store_dwordx4 v[112:115], v5, s[40:43], s60 offen sc1
L_qg:
    s_barrier
    s_lshl_b32 s52, s26, 14
    s_lshl_b32 s53, s29, 8
    s_add_u32 s52, s52, s53
    s_add_u32 s52, s52, 65536
    s_add_u32 s53, s52, 4096
    s_add_u32 s54, s52, 8192
    s_add_u32 s55, s52, 12288
    v_lshlrev_b32 v5, 10, v1
    v_lshl_add_u32 v5, v2, 4, v5
    v_lshlrev_b32 v6, 3, v0
    v_add_u32 v6, 155648, v6
    s_mov_b32 s56, 0x04000c0c
    s_mov_b32 s57, 0x0706000c
    s_lshl_b32 s58, s26, 11
    s_lshl_b32 s59, s29, 8
    s_add_u32 s58, s58, s59
    s_add_u32 s58, s58, 196608
    v_lshlrev_b32 v7, 4, v2
    s_mov_b32 s62, 0
    s_mov_b32 s63, 0xffff0000
    s_mov_b32 s69, 200000
L_pq_1:
    buffer_load_dwordx4 v[16:19], v5, s[40:43], s52 offen sc1
    buffer_load_dwordx4 v[20:23], v5, s[40:43], s53 offen sc1
    buffer_load_dwordx4 v[24:27], v5, s[40:43], s54 offen sc1
    buffer_load_dwordx4 v[28:31], v5, s[40:43], s55 offen sc1
    s_mov_b64 s[66:67], exec
    s_and_b64 exec, exec, s[62:63]
    s_cbranch_execz L_qx_2
    buffer_load_dwordx4 v[32:35], v7, s[40:43], s58 offen sc1
    buffer_load_dwordx4 v[36:39], v7, s[40:43], s58 offen offset:1024 sc1
L_qx_2:
    s_mov_b64 exec, s[66:67]
    s_waitcnt vmcnt(0)
    v_xor_b32 v35, v35, v32
    v_xor_b32 v35, v35, v33
    v_xor_b32 v35, v35, v34
    v_xor_b32 v39, v39, v36
    v_xor_b32 v39, v39, v37
    v_xor_b32 v39, v39, v38
    v_cmp_ne_u32 s[66:67], s31, v35
    v_cmp_ne_u32 vcc, s31, v39
    s_or_b64 s[66:67], s[66:67], vcc
    s_and_b64 s[66:67], s[66:67], s[62:63]
    v_xor_b32 v19, v19, v16
    v_xor_b32 v23, v23, v20
    v_xor_b32 v27, v27, v24
    v_xor_b32 v31, v31, v28
    v_xor_b32 v19, v19, v17
    v_xor_b32 v23, v23, v21
    v_xor_b32 v27, v27, v25
    v_xor_b32 v31, v31, v29
    v_xor_b32 v19, v19, v18
    v_xor_b32 v23, v23, v22
    v_xor_b32 v27, v27, v26
    v_xor_b32 v31, v31, v30
    v_max3_u32 v8, v19, v23, v27
    v_max_u32 v8, v8, v31
    v_min3_u32 v9, v19, v23, v27
    v_min_u32 v9, v9, v31
    v_cmp_ne_u32 s[64:65], s31, v8
    v_cmp_ne_u32 vcc, s31, v9
    s_or_b64 vcc, vcc, s[64:65]
    s_or_b64 vcc, vcc, s[66:67]
    s_cmp_eq_u64 vcc, 0
    s_cbranch_scc1 L_pq_1_d
    s_sub_u32 s69, s69, 1
    s_cbranch_scc1 L_pq_1_d
    s_mov_b64 exec, vcc
    s_sleep 6
    s_branch L_pq_1
L_pq_1_d:
    s_mov_b64 exec, -1
    v_perm_b32 v19, v16, v17, s56
    v_perm_b32 v19, v19, v18, s57
    v_and_b32 v16, 0xffffff00, v16
    v_and_b32 v17, 0xffffff00, v17
    v_and_b32 v18, 0xffffff00, v18
    v_perm_b32 v23, v20, v21, s56
    v_perm_b32 v23, v23, v22, s57
    v_and_b32 v20, 0xffffff00, v20
    v_and_b32 v21, 0xffffff00, v21
    v_and_b32 v22, 0xffffff00, v22
    v_perm_b32 v27, v24, v25, s56
    v_perm_b32 v27, v27, v26, s57
    v_and_b32 v24, 0xffffff00, v24
    v_and_b32 v25, 0xffffff00, v25
    v_and_b32 v26, 0xffffff00, v26
    v_perm_b32 v31, v28, v29, s56
    v_perm_b32 v31, v31, v30, s57
    v_and_b32 v28, 0xffffff00, v28
    v_and_b32 v29, 0xffffff00, v29
    v_and_b32 v30, 0xffffff00, v30
    v_perm_b32 v35, v32, v33, s56
    v_perm_b32 v35, v35, v34, s57
    v_and_b32 v32, 0xffffff00, v32
    v_and_b32 v33, 0xffffff00, v33
    v_and_b32 v34, 0xffffff00, v34
    v_perm_b32 v39, v36, v37, s56
    v_perm_b32 v39, v39, v38, s57
    v_and_b32 v36, 0xffffff00, v36
    v_and_b32 v37, 0xffffff00, v37
    v_and_b32 v38, 0xffffff00, v38
    s_mov_b64 exec, s[62:63]
    v_add_f32 v16, v16, v32
    v_add_f32 v24, v24, v36
    v_add_f32 v17, v17, v33
    v_add_f32 v25, v25, v37
    v_add_f32 v18, v18, v34
    v_add_f32 v26, v26, v38
    v_add_f32 v19, v19, v35
    v_add_f32 v27, v27, v39
    s_mov_b64 exec, -1
    v_add_f32 v16, v16, v24
    v_add_f32 v17, v17, v25
    v_add_f32 v18, v18, v26
    v_add_f32 v19, v19, v27
    v_cvt_pk_bf16_f32 v16, v16, v17
    v_cvt_pk_bf16_f32 v17, v18, v19
    ds_write_b64 v6, v[16:17] offset:0
    v_add_f32 v20, v20, v28
    v_add_f32 v21, v21, v29
    v_add_f32 v22, v22, v30
    v_add_f32 v23, v23, v31
    v_cvt_pk_bf16_f32 v20, v20, v21
    v_cvt_pk_bf16_f32 v21, v22, v23
    ds_write_b64 v6, v[20:21] offset:512
    s_waitcnt lgkmcnt(0)
    s_branch L_Hb1
L_H23:
    s_waitcnt lgkmcnt(0)
    s_load_dwordx4 s[20:23], s[0:1], 64
    s_load_dwordx2 s[24:25], s[0:1], 80
    s_waitcnt lgkmcnt(0)
    s_load_dword s31, s[24:25], 0
    s_mov_b32 s40, s24
    s_mov_b32 s41, s25
    s_mov_b32 s42, 1900544
    s_mov_b32 s43, 0x20000
    s_waitcnt lgkmcnt(0)
    s_add_u32 s31, s31, 0x9e3779b9
    s_cmp_eq_u32 s28, 2
    s_cbranch_scc0 L_noid
    s_lshl_b32 s52, s26, 8
    s_lshl_b32 s53, s27, 3
    s_add_u32 s52, s52, s53
    s_add_u32 s52, s52, 40960
    s_getreg_b32 s54, hwreg(HW_REG_XCC_ID, 0, 4)
    v_mov_b32 v6, s54
    v_mov_b32 v7, s31
    v_mov_b32 v5, 0
    s_mov_b64 exec, 1
    buffer_store_dwordx2 v[6:7], v5, s[40:43], s52 offen sc1
    s_mov_b64 exec, -1
L_noid:
    s_barrier
    s_cmp_eq_u32 s28, 0
    s_cbranch_scc1 L_qg
    s_barrier
L_Hb1:
    s_barrier
    s_sub_u32 s56, s27, 23
    s_cmp_lt_u32 s56, 7
    s_cselect_b32 s58, s28, 0
    s_cmp_eq_u32 s58, 3
    s_cbranch_scc0 L_noh1
    s_lshl_b32 s52, s56, 13
    s_add_u32 s52, s52, 589824
    s_add_u32 s53, s52, 4096
    v_lshlrev_b32 v3, 4, v0
    buffer_load_dwordx4 v[32:35], v3, s[40:43], s52 offen offset:0 sc1
    buffer_load_dwordx4 v[36:39], v3, s[40:43], s52 offen offset:1024 sc1
    buffer_load_dwordx4 v[40:43], v3, s[40:43], s52 offen offset:2048 sc1
    buffer_load_dwordx4 v[44:47], v3, s[40:43], s52 offen offset:3072 sc1
    buffer_load_dwordx4 v[48:51], v3, s[40:43], s53 offen offset:0 sc1
    buffer_load_dwordx4 v[52:55], v3, s[40:43], s53 offen offset:1024 sc1
    buffer_load_dwordx4 v[56:59], v3, s[40:43], s53 offen offset:2048 sc1
    buffer_load_dwordx4 v[60:63], v3, s[40:43], s53 offen offset:3072 sc1
L_noh1:
    s_lshl_b32 s62, s26, 8
    s_add_u32 s62, s62, 40960
    v_and_b32 v30, 31, v0
    v_lshlrev_b32 v30, 3, v30
    s_cmp_eq_u32 s28, 0
    s_cbranch_scc0 L_noid2
    buffer_load_dwordx2 v[30:31], v30, s[40:43], s62 offen sc1
L_noid2:
    s_barrier
    s_barrier
    s_mov_b32 s101, 0
    s_cmp_eq_u32 s28, 0
    s_cbranch_scc0 L_noid3
    s_getreg_b32 s62, hwreg(HW_REG_XCC_ID, 0, 4)
    s_waitcnt vmcnt(0)
    v_cmp_ne_u32 s[64:65], s31, v31
    v_cmp_ne_u32 vcc, s62, v30
    s_or_b64 vcc, vcc, s[64:65]
    s_cmp_eq_u64 vcc, 0
    s_cselect_b32 s101, 1, 0
    v_mov_b32 v30, 157712
    v_mov_b32 v31, s101
    ds_write_b32 v30, v31
L_noid3:
    s_cmp_eq_u32 s58, 3
    s_cbranch_scc0 L_noh2
    v_lshlrev_b32 v6, 9, v1
    v_lshl_add_u32 v6, v2, 3, v6
    v_add_u32 v6, 159744, v6
    s_mov_b32 s56, 0x04000c0c
    s_mov_b32 s57, 0x0706000c
    s_mov_b32 s69, 200000
L_ph_3:
    s_waitcnt vmcnt(0)
    v_xor_b32 v35, v35, v32
    v_xor_b32 v39, v39, v36
    v_xor_b32 v43, v43, v40
    v_xor_b32 v47, v47, v44
    v_xor_b32 v51, v51, v48
    v_xor_b32 v55, v55, v52
    v_xor_b32 v59, v59, v56
    v_xor_b32 v63, v63, v60
    v_xor_b32 v35, v35, v33
    v_xor_b32 v39, v39, v37
    v_xor_b32 v43, v43, v41
    v_xor_b32 v47, v47, v45
    v_xor_b32 v51, v51, v49
    v_xor_b32 v55, v55, v53
    v_xor_b32 v59, v59, v57
    v_xor_b32 v63, v63, v61
    v_xor_b32 v35, v35, v34
    v_xor_b32 v39, v39, v38
    v_xor_b32 v43, v43, v42
    v_xor_b32 v47, v47, v46
    v_xor_b32 v51, v51, v50
    v_xor_b32 v55, v55, v54
    v_xor_b32 v59, v59, v58
    v_xor_b32 v63, v63, v62
    v_max3_u32 v8, v35, v39, v43
    v_max3_u32 v8, v8, v47, v51
    v_max3_u32 v8, v8, v55, v59
    v_max_u32 v8, v8, v63
    v_min3_u32 v9, v35, v39, v43
    v_min3_u32 v9, v9, v47, v51
    v_min3_u32 v9, v9, v55, v59
    v_min_u32 v9, v9, v63
    v_cmp_ne_u32 s[64:65], s31, v8
    v_cmp_ne_u32 vcc, s31, v9
    s_or_b64 vcc, vcc, s[64:65]
    s_cmp_eq_u64 vcc, 0
    s_cbranch_scc1 L_ph_3_d
    s_sub_u32 s69, s69, 1
    s_cbranch_scc1 L_ph_3_d
    s_sleep 4
    buffer_load_dwordx4 v[32:35], v3, s[40:43], s52 offen offset:0 sc1
    buffer_load_dwordx4 v[36:39], v3, s[40:43], s52 offen offset:1024 sc1
    buffer_load_dwordx4 v[40:43], v3, s[40:43], s52 offen offset:2048 sc1
    buffer_load_dwordx4 v[44:47], v3, s[40:43], s52 offen offset:3072 sc1
    buffer_load_dwordx4 v[48:51], v3, s[40:43], s53 offen offset:0 sc1
    buffer_load_dwordx4 v[52:55], v3, s[40:43], s53 offen offset:1024 sc1
    buffer_load_dwordx4 v[56:59], v3, s[40:43], s53 offen offset:2048 sc1
    buffer_load_dwordx4 v[60:63], v3, s[40:43], s53 offen offset:3072 sc1
    s_branch L_ph_3
L_ph_3_d:
    v_perm_b32 v35, v32, v33, s56
    v_perm_b32 v35, v35, v34, s57
    v_and_b32 v32, 0xffffff00, v32
    v_and_b32 v33, 0xffffff00, v33
    v_and_b32 v34, 0xffffff00, v34
    v_perm_b32 v39, v36, v37, s56
    v_perm_b32 v39, v39, v38, s57
    v_and_b32 v36, 0xffffff00, v36
    v_and_b32 v37, 0xffffff00, v37
    v_and_b32 v38, 0xffffff00, v38
    v_perm_b32 v43, v40, v41, s56
    v_perm_b32 v43, v43, v42, s57
    v_and_b32 v40, 0xffffff00, v40
    v_and_b32 v41, 0xffffff00, v41
    v_and_b32 v42, 0xffffff00, v42
    v_perm_b32 v47, v44, v45, s56
    v_perm_b32 v47, v47, v46, s57
    v_and_b32 v44, 0xffffff00, v44
    v_and_b32 v45, 0xffffff00, v45
    v_and_b32 v46, 0xffffff00, v46
    v_perm_b32 v51, v48, v49, s56
    v_perm_b32 v51, v51, v50, s57
    v_and_b32 v48, 0xffffff00, v48
    v_and_b32 v49, 0xffffff00, v49
    v_and_b32 v50, 0xffffff00, v50
    v_perm_b32 v55, v52, v53, s56
    v_perm_b32 v55, v55, v54, s57
    v_and_b32 v52, 0xffffff00, v52
    v_and_b32 v53, 0xffffff00, v53
    v_and_b32 v54, 0xffffff00, v54
    v_perm_b32 v59, v56, v57, s56
    v_perm_b32 v59, v59, v58, s57
    v_and_b32 v56, 0xffffff00, v56
    v_and_b32 v57, 0xffffff00, v57
    v_and_b32 v58, 0xffffff00, v58
    v_perm_b32 v63, v60, v61, s56
    v_perm_b32 v63, v63, v62, s57
    v_and_b32 v60, 0xffffff00, v60
    v_and_b32 v61, 0xffffff00, v61
    v_and_b32 v62, 0xffffff00, v62
    v_add_f32 v32, v32, v36
    v_add_f32 v33, v33, v37
    v_add_f32 v34, v34, v38
    v_add_f32 v35, v35, v39
    v_max_f32 v32, 0, v32
    v_max_f32 v33, 0, v33
    v_max_f32 v34, 0, v34
    v_max_f32 v35, 0, v35
    v_cvt_pk_bf16_f32 v32, v32, v33
    v_cvt_pk_bf16_f32 v33, v34, v35
    ds_write_b64 v6, v[32:33] offset:0
    v_add_f32 v40, v40, v44
    v_add_f32 v41, v41, v45
    v_add_f32 v42, v42, v46
    v_add_f32 v43, v43, v47
    v_max_f32 v40, 0, v40
    v_max_f32 v41, 0, v41
    v_max_f32 v42, 0, v42
    v_max_f32 v43, 0, v43
    v_cvt_pk_bf16_f32 v40, v40, v41
    v_cvt_pk_bf16_f32 v41, v42, v43
    ds_write_b64 v6, v[40:41] offset:128
    v_add_f32 v48, v48, v52
    v_add_f32 v49, v49, v53
    v_add_f32 v50, v50, v54
    v_add_f32 v51, v51, v55
    v_max_f32 v48, 0, v48
    v_max_f32 v49, 0, v49
    v_max_f32 v50, 0, v50
    v_max_f32 v51, 0, v51
    v_cvt_pk_bf16_f32 v48, v48, v49
    v_cvt_pk_bf16_f32 v49, v50, v51
    ds_write_b64 v6, v[48:49] offset:256
    v_add_f32 v56, v56, v60
    v_add_f32 v57, v57, v61
    v_add_f32 v58, v58, v62
    v_add_f32 v59, v59, v63
    v_max_f32 v56, 0, v56
    v_max_f32 v57, 0, v57
    v_max_f32 v58, 0, v58
    v_max_f32 v59, 0, v59
    v_cvt_pk_bf16_f32 v56, v56, v57
    v_cvt_pk_bf16_f32 v57, v58, v59
    ds_write_b64 v6, v[56:57] offset:384
L_noh2:
    s_cmp_eq_u32 s28, 2
    s_cbranch_scc0 L_nolse
    v_lshlrev_b32 v3, 2, v0
    ds_read2st64_b32 v[6:7], v3 offset0:32 offset1:33
    ds_read2st64_b32 v[8:9], v3 offset0:34 offset1:35
    v_lshlrev_b32 v4, 4, v1
    v_add_u32 v4, 156672, v4
    ds_read2st64_b32 v[10:11], v4 offset0:0 offset1:1
    ds_read2st64_b32 v[12:13], v4 offset0:2 offset1:3
    s_mov_b32 s98, 0x3fb8aa3b
    s_lshl_b32 s52, s26, 12
    s_lshl_b32 s53, s29, 10
    s_add_u32 s52, s52, s53
    s_add_u32 s52, s52, 4096
    s_lshl_b32 s53, s30, 7
    s_add_u32 s53, s53, s52
    s_waitcnt lgkmcnt(0)
    v_add_f32 v6, v6, v7
    v_add_f32 v8, v8, v9
    v_max3_f32 v10, v10, v11, v12
    v_add_f32 v6, v6, v8
    v_max_f32 v10, v10, v13
    v_rcp_f32 v11, v6
    v_log_f32 v6, v6
    v_mul_f32 v10, s98, v10
    v_lshlrev_b32 v5, 3, v1
    v_add_f32 v6, v6, v10
    v_mov_b32 v7, s31
    v_cmp_eq_u32 vcc, 0, v2
    s_and_saveexec_b64 s[64:65], vcc
    buffer_store_dwordx2 v[6:7], v5, s[40:43], s53 offen sc1
    s_mov_b64 exec, s[64:65]
    v_lshlrev_b32 v5, 2, v1
    v_add_u32 v5, 157696, v5
    v_cmp_eq_u32 vcc, 0, v2
    s_and_saveexec_b64 s[64:65], vcc
    ds_write_b32 v5, v11
    s_mov_b64 exec, s[64:65]
L_nolse:
    v_lshrrev_b32 v10, 2, v2
    v_and_b32 v11, 3, v2
    v_lshlrev_b32 v4, 10, v1
    v_lshl_add_u32 v4, v10, 7, v4
    v_lshl_add_u32 v4, v11, 3, v4
    s_lshl_b32 s52, s28, 5
    v_add_u32 v4, s52, v4
    v_lshlrev_b32 v6, 9, v11
    v_lshl_add_u32 v6, v1, 4, v6
    v_add_u32 v6, 159744, v6
    v_lshlrev_b32 v9, 6, v2
    v_lshl_add_u32 v9, v1, 4, v9
    v_mov_b32 v17, s31
    v_mov_b32 v19, s31
    s_waitcnt lgkmcnt(0)
    s_barrier
    s_cmp_eq_u32 s28, 1
    s_cbranch_scc0 L_noid4
    v_mov_b32 v30, 157712
    ds_read_b32 v30, v30
    s_waitcnt lgkmcnt(0)
    v_readfirstlane_b32 s101, v30
L_noid4:
    s_sub_u32 s56, s27, 23
    s_cmp_ge_u32 s56, 7
    s_cbranch_scc1 L_nog2
    v_add_u32 v7, 131072, v4
    ds_read_b64_tr_b16 v[64:65], v7 offset:0
    ds_read_b64_tr_b16 v[66:67], v7 offset:512
    ds_read_b64_tr_b16 v[68:69], v7 offset:4096
    ds_read_b64_tr_b16 v[70:71], v7 offset:4608
    ds_read_b64_tr_b16 v[72:73], v7 offset:8192
    ds_read_b64_tr_b16 v[74:75], v7 offset:8704
    ds_read_b64_tr_b16 v[76:77], v7 offset:12288
    ds_read_b64_tr_b16 v[78:79], v7 offset:12800
    s_waitcnt lgkmcnt(4)
    ds_read_b64_tr_b16 v[80:81], v7 offset:16384
    ds_read_b64_tr_b16 v[82:83], v7 offset:16896
    ds_read_b64_tr_b16 v[84:85], v7 offset:20480
    ds_read_b64_tr_b16 v[86:87], v7 offset:20992
    ds_read_b64_tr_b16 v[88:89], v4 offset:16384
    ds_read_b64_tr_b16 v[90:91], v4 offset:16896
    ds_read_b64_tr_b16 v[92:93], v4 offset:20480
    ds_read_b64_tr_b16 v[94:95], v4 offset:20992
    s_waitcnt lgkmcnt(4)
    ds_read_b128 v[128:131], v6 offset:0
    ds_read_b128 v[132:135], v6 offset:64
    ds_read_b128 v[136:139], v6 offset:128
    ds_read_b128 v[140:143], v6 offset:192
    ds_read_b128 v[144:147], v6 offset:256
    ds_read_b128 v[148:151], v6 offset:320
    ds_read_b128 v[152:155], v6 offset:384
    ds_read_b128 v[156:159], v6 offset:448
    s_waitcnt lgkmcnt(0)
    v_mfma_f32_16x16x32_bf16 v[12:15], v[64:67], v[128:131], 0
    v_mfma_f32_16x16x32_bf16 v[12:15], v[68:71], v[132:135], v[12:15]
    v_mfma_f32_16x16x32_bf16 v[12:15], v[72:75], v[136:139], v[12:15]
    v_mfma_f32_16x16x32_bf16 v[12:15], v[76:79], v[140:143], v[12:15]
    v_mfma_f32_16x16x32_bf16 v[12:15], v[80:83], v[144:147], v[12:15]
    v_mfma_f32_16x16x32_bf16 v[12:15], v[84:87], v[148:151], v[12:15]
    v_mfma_f32_16x16x32_bf16 v[12:15], v[88:91], v[152:155], v[12:15]
    v_mfma_f32_16x16x32_bf16 v[12:15], v[92:95], v[156:159], v[12:15]
    s_nop 7
    v_cvt_pk_bf16_f32 v20, v12, v13
    v_cvt_pk_bf16_f32 v22, v14, v15
    s_lshl_b32 s52, s26, 15
    s_lshl_b32 s53, s56, 10
    s_add_u32 s52, s52, s53
    s_lshl_b32 s53, s28, 8
    s_add_u32 s52, s52, s53
    s_add_u32 s52, s52, 1638400
    v_mov_b32 v21, s31
    v_mov_b32 v23, s31
    v_cmp_gt_u32 vcc, 4, v2
    s_and_saveexec_b64 s[64:65], vcc
    buffer_store_dwordx4 v[20:23], v9, s[40:43], s52 offen sc1
    s_mov_b64 exec, s[64:65]
L_nog2:
    v_lshrrev_b32 v24, 5, v0
    s_lshl_b32 s52, s28, 1
    v_add_u32 v24, s52, v24
    v_and_b32 v25, 31, v0
    v_lshlrev_b32 v25, 4, v25
    v_lshl_add_u32 v26, v24, 9, v25
    v_lshl_add_u32 v27, v24, 14, v25
    v_lshlrev_b32 v28, 2, v24
    v_add_u32 v28, 157696, v28
    s_lshl_b32 s63, s26, 16
    s_lshl_b32 s53, s30, 11
    s_add_u32 s63, s63, s53
    s_lshl_b32 s53, s29, 9
    s_add_u32 s63, s63, s53
    s_add_u32 s63, s63, 851968
    v_mov_b32 v81, s31
    v_mov_b32 v83, s31
    s_lshl_b32 s66, s26, 2
    s_add_u32 s66, s66, s29
    s_lshl_b32 s66, s66, 10
    s_lshl_b32 s53, s30, 15
    s_add_u32 s66, s66, s53
    s_lshl_b32 s53, s28, 8
    s_add_u32 s66, s66, s53
    s_add_u32 s66, s66, 1376256
    v_and_b32 v12, 3, v2
    v_lshlrev_b32 v12, 8, v12
    v_lshl_add_u32 v12, v1, 4, v12
    v_add_u32 v12, 10240, v12
    v_add_u32 v4, 32768, v4
    s_lshl_b32 s67, s26, 12
    s_lshr_b32 s68, s28, 1
    s_lshl_b32 s68, s68, 10
    s_add_u32 s67, s67, s68
    s_lshl_b32 s68, s29, 3
    s_add_u32 s67, s67, s68
    s_add_u32 s67, s67, 4096
    v_lshlrev_b32 v104, 7, v1
    s_lshl_b32 s14, s26, 16
    s_lshl_b32 s15, s29, 14
    s_add_u32 s14, s14, s15
    s_lshl_b32 s15, s28, 8
    s_add_u32 s14, s14, s15
    s_add_u32 s14, s14, 851968
    s_add_u32 s15, s14, 8192
    v_lshlrev_b32 v105, 11, v1
    v_lshl_add_u32 v105, v2, 4, v105
    s_lshl_b32 s61, s28, 7
    s_add_u32 s61, s61, 10240
    v_lshlrev_b32 v112, 3, v2
    v_lshl_add_u32 v112, v1, 1, v112
    v_add_u32 v112, s61, v112
    s_barrier
    s_cmp_lt_u32 s28, 2
    s_cbranch_scc0 L_nopub
    ds_read_b128 v[64:67], v26 offset:0
    ds_read_b128 v[68:71], v26 offset:2048
    ds_read_b128 v[72:75], v26 offset:4096
    ds_read_b128 v[76:79], v26 offset:6144
    ds_read_b32 v29, v28
    s_waitcnt lgkmcnt(0)
    v_add_f32 v64, v64, v68
    v_add_f32 v72, v72, v76
    v_add_f32 v65, v65, v69
    v_add_f32 v73, v73, v77
    v_add_f32 v66, v66, v70
    v_add_f32 v74, v74, v78
    v_add_f32 v67, v67, v71
    v_add_f32 v75, v75, v79
    v_add_f32 v64, v64, v72
    v_add_f32 v65, v65, v73
    v_add_f32 v66, v66, v74
    v_add_f32 v67, v67, v75
    v_mul_f32 v64, v64, v29
    v_mul_f32 v65, v65, v29
    v_mul_f32 v66, v66, v29
    v_mul_f32 v67, v67, v29
    v_cvt_pk_bf16_f32 v80, v64, v65
    v_cvt_pk_bf16_f32 v82, v66, v67
    s_cmp_eq_u32 s101, 1
    s_cbranch_scc1 L_publ
    buffer_store_dwordx4 v[80:83], v27, s[40:43], s63 offen sc1
    s_branch L_pubs
L_publ:
    buffer_store_dwordx4 v[80:83], v27, s[40:43], s63 offen
L_pubs:
L_nopub:
L_wts2:
    buffer_load_dwordx2 v[106:107], v104, s[40:43], s67 offen sc1
    buffer_load_dwordx2 v[108:109], v104, s[40:43], s67 offen offset:512 sc1
    buffer_load_dwordx4 v[48:51], v105, s[40:43], s14 offen sc1
    buffer_load_dwordx4 v[52:55], v105, s[40:43], s15 offen sc1
    s_waitcnt vmcnt(2)
    s_mov_b32 s69, 200000
    s_branch L_pw_4_c
L_pw_4:
    s_waitcnt vmcnt(0)
L_pw_4_c:
    v_cmp_ne_u32 s[64:65], s31, v107
    v_cmp_ne_u32 vcc, s31, v109
    s_or_b64 vcc, vcc, s[64:65]
    s_cmp_eq_u64 vcc, 0
    s_cbranch_scc1 L_pw_4_d
    s_sub_u32 s69, s69, 1
    s_cbranch_scc1 L_pw_4_d
    s_mov_b64 exec, vcc
    s_sleep 2
    buffer_load_dwordx2 v[106:107], v104, s[40:43], s67 offen sc1
    buffer_load_dwordx2 v[108:109], v104, s[40:43], s67 offen offset:512 sc1
    s_branch L_pw_4
L_pw_4_d:
    s_mov_b64 exec, -1
    v_max_f32 v110, v106, v108
    v_mov_b32 v111, v110
    s_nop 1
    v_permlane32_swap_b32 v111, v110
    s_nop 1
    v_max_f32 v110, v111, v110
    v_mov_b32 v111, v110
    s_nop 1
    v_permlane16_swap_b32 v111, v110
    s_nop 1
    v_max_f32 v110, v111, v110
    v_sub_f32 v106, v106, v110
    v_sub_f32 v108, v108, v110
    v_exp_f32 v106, v106
    v_exp_f32 v108, v108
    s_nop 0
    v_add_f32 v110, v106, v108
    v_mov_b32 v111, v110
    s_nop 1
    v_permlane32_swap_b32 v111, v110
    s_nop 1
    v_add_f32 v110, v111, v110
    v_mov_b32 v111, v110
    s_nop 1
    v_permlane16_swap_b32 v111, v110
    s_nop 1
    v_add_f32 v110, v111, v110
    v_rcp_f32 v110, v110
    s_nop 0
    v_mul_f32 v111, v108, v110
    v_mul_f32 v110, v106, v110
    s_mov_b32 s69, 200000
    s_branch L_po_5_c
L_po_5:
    buffer_load_dwordx4 v[48:51], v105, s[40:43], s14 offen sc1
    buffer_load_dwordx4 v[52:55], v105, s[40:43], s15 offen sc1
L_po_5_c:
    s_waitcnt vmcnt(0)
    v_max3_u32 v8, v49, v51, v53
    v_max_u32 v8, v8, v55
    v_min3_u32 v7, v49, v51, v53
    v_min_u32 v7, v7, v55
    v_cmp_ne_u32 s[64:65], s31, v8
    v_cmp_ne_u32 vcc, s31, v7
    s_or_b64 vcc, vcc, s[64:65]
    s_cmp_eq_u64 vcc, 0
    s_cbranch_scc1 L_po_5_d
    s_sub_u32 s69, s69, 1
    s_cbranch_scc1 L_po_5_d
    s_mov_b64 exec, vcc
    s_sleep 1
    s_branch L_po_5
L_po_5_d:
    s_mov_b64 exec, -1
    v_lshlrev_b32 v56, 16, v48
    v_and_b32 v57, s96, v48
    v_lshlrev_b32 v58, 16, v50
    v_and_b32 v59, s96, v50
    v_lshlrev_b32 v60, 16, v52
    v_and_b32 v61, s96, v52
    v_lshlrev_b32 v62, 16, v54
    v_and_b32 v63, s96, v54
    v_mul_f32 v56, v56, v110
    v_mul_f32 v57, v57, v110
    v_mul_f32 v58, v58, v110
    v_mul_f32 v59, v59, v110
    v_fmac_f32 v56, v60, v111
    v_fmac_f32 v57, v61, v111
    v_fmac_f32 v58, v62, v111
    v_fmac_f32 v59, v63, v111
    s_nop 0
    v_permlane32_swap_b32 v56, v58
    v_permlane32_swap_b32 v57, v59
    s_nop 0
    v_add_f32 v56, v56, v58
    v_add_f32 v57, v57, v59
    s_nop 1
    v_permlane16_swap_b32 v56, v57
    s_nop 1
    v_add_f32 v56, v56, v57
    v_cvt_pk_bf16_f32 v56, v56, v56
    ds_write_b16 v112, v56
    s_waitcnt vmcnt(0) lgkmcnt(0)
    s_barrier
    s_cmp_lt_u32 s28, 4
    s_cbranch_scc0 L_final
    ds_read_b128 v[96:99], v12 offset:0
    ds_read_b64_tr_b16 v[32:33], v4 offset:0
    ds_read_b64_tr_b16 v[34:35], v4 offset:512
    ds_read_b128 v[100:103], v12 offset:64
    ds_read_b64_tr_b16 v[36:37], v4 offset:4096
    ds_read_b64_tr_b16 v[38:39], v4 offset:4608
    ds_read_b128 v[104:107], v12 offset:128
    ds_read_b64_tr_b16 v[40:41], v4 offset:8192
    ds_read_b64_tr_b16 v[42:43], v4 offset:8704
    ds_read_b128 v[108:111], v12 offset:192
    ds_read_b64_tr_b16 v[44:45], v4 offset:12288
    ds_read_b64_tr_b16 v[46:47], v4 offset:12800
    v_cmp_gt_u32 vcc, 4, v2
    s_waitcnt lgkmcnt(9)
    v_mfma_f32_16x16x32_bf16 v[12:15], v[32:35], v[96:99], 0
    s_waitcnt lgkmcnt(6)
    v_mfma_f32_16x16x32_bf16 v[12:15], v[36:39], v[100:103], v[12:15]
    s_waitcnt lgkmcnt(3)
    v_mfma_f32_16x16x32_bf16 v[12:15], v[40:43], v[104:107], v[12:15]
    s_waitcnt lgkmcnt(0)
    v_mfma_f32_16x16x32_bf16 v[12:15], v[44:47], v[108:111], v[12:15]
    s_nop 7
    v_cvt_pk_bf16_f32 v16, v12, v13
    v_cvt_pk_bf16_f32 v18, v14, v15
    s_and_saveexec_b64 s[64:65], vcc
    buffer_store_dwordx4 v[16:19], v9, s[40:43], s66 offen sc1
    s_endpgm
L_final:
    s_cmp_gt_u32 s28, 5
    s_cbranch_scc0 L_fin0
    s_endpgm
L_fin0:
    v_lshrrev_b32 v3, 1, v0
    v_lshlrev_b32 v3, 10, v3
    v_and_b32 v4, 1, v0
    v_lshl_add_u32 v3, v4, 4, v3
    s_lshl_b32 s52, s26, 15
    s_lshl_b32 s53, s29, 6
    s_add_u32 s52, s52, s53
    s_lshr_b32 s53, s30, 1
    s_lshl_b32 s53, s53, 8
    s_add_u32 s52, s52, s53
    s_and_b32 s53, s30, 1
    s_lshl_b32 s53, s53, 5
    s_add_u32 s52, s52, s53
    s_lshl_b32 s56, s29, 10
    s_lshl_b32 s57, s26, 7
    s_add_u32 s56, s56, s57
    s_lshl_b32 s57, s30, 4
    s_add_u32 s56, s56, s57
    v_lshlrev_b32 v5, 3, v4
    v_lshlrev_b32 v6, 5, v4
    v_add_u32 v6, 12288, v6
    s_cmp_eq_u32 s28, 4
    s_cbranch_scc1 L_fins
    s_add_u32 s54, s52, 1638400
    v_cmp_gt_u32 s[66:67], 14, v0
    v_cmp_eq_u32 vcc, 1, v4
    v_mov_b32 v20, s48
    v_mov_b32 v21, s49
    v_mov_b32 v22, s50
    v_mov_b32 v23, s51
    v_cndmask_b32 v20, v20, v22, vcc
    v_cndmask_b32 v21, v21, v23, vcc
    s_mov_b32 s69, 200000
L_pgp_6:
    buffer_load_dwordx4 v[32:35], v3, s[40:43], s54 offen sc1
    s_waitcnt vmcnt(0)
    v_cmp_ne_u32 s[64:65], s31, v33
    v_cmp_ne_u32 vcc, s31, v35
    s_or_b64 vcc, vcc, s[64:65]
    s_and_b64 vcc, vcc, s[66:67]
    s_cmp_eq_u64 vcc, 0
    s_cbranch_scc1 L_pgp_6_d
    s_sub_u32 s69, s69, 1
    s_cbranch_scc1 L_pgp_6_d
    s_mov_b64 exec, vcc
    s_sleep 1
    s_branch L_pgp_6
L_pgp_6_d:
    s_mov_b64 exec, -1
    v_cndmask_b32 v32, 0, v32, s[66:67]
    v_cndmask_b32 v34, 0, v34, s[66:67]
    v_lshlrev_b32 v24, 16, v32
    v_and_b32 v25, s96, v32
    v_lshlrev_b32 v26, 16, v34
    v_and_b32 v27, s96, v34
    s_nop 0
    v_add_f32_dpp v24, v24, v24 row_ror:2 row_mask:0xf bank_mask:0xf
    v_add_f32_dpp v25, v25, v25 row_ror:2 row_mask:0xf bank_mask:0xf
    v_add_f32_dpp v26, v26, v26 row_ror:2 row_mask:0xf bank_mask:0xf
    v_add_f32_dpp v27, v27, v27 row_ror:2 row_mask:0xf bank_mask:0xf
    v_add_f32_dpp v24, v24, v24 row_ror:4 row_mask:0xf bank_mask:0xf
    v_add_f32_dpp v25, v25, v25 row_ror:4 row_mask:0xf bank_mask:0xf
    v_add_f32_dpp v26, v26, v26 row_ror:4 row_mask:0xf bank_mask:0xf
    v_add_f32_dpp v27, v27, v27 row_ror:4 row_mask:0xf bank_mask:0xf
    v_add_f32_dpp v24, v24, v24 row_ror:8 row_mask:0xf bank_mask:0xf
    v_add_f32_dpp v25, v25, v25 row_ror:8 row_mask:0xf bank_mask:0xf
    v_add_f32_dpp v26, v26, v26 row_ror:8 row_mask:0xf bank_mask:0xf
    v_add_f32_dpp v27, v27, v27 row_ror:8 row_mask:0xf bank_mask:0xf
    v_mov_b32 v28, v24
    v_mov_b32 v29, v25
    v_mov_b32 v30, v26
    v_mov_b32 v31, v27
    s_nop 0
    v_permlane16_swap_b32 v28, v24
    v_permlane16_swap_b32 v29, v25
    v_permlane16_swap_b32 v30, v26
    v_permlane16_swap_b32 v31, v27
    v_add_f32 v24, v24, v28
    v_add_f32 v25, v25, v29
    v_add_f32 v26, v26, v30
    v_add_f32 v27, v27, v31
    v_mov_b32 v28, v24
    v_mov_b32 v29, v25
    v_mov_b32 v30, v26
    v_mov_b32 v31, v27
    s_nop 0
    v_permlane32_swap_b32 v28, v24
    v_permlane32_swap_b32 v29, v25
    v_permlane32_swap_b32 v30, v26
    v_permlane32_swap_b32 v31, v27
    v_add_f32 v24, v24, v28
    v_add_f32 v25, v25, v29
    v_add_f32 v26, v26, v30
    v_add_f32 v27, v27, v31
    v_cvt_pk_bf16_f32 v8, v24, v25
    v_cvt_pk_bf16_f32 v9, v26, v27
    v_lshlrev_b32 v24, 16, v8
    v_and_b32 v25, s96, v8
    v_lshlrev_b32 v26, 16, v9
    v_and_b32 v27, s96, v9
    s_mov_b32 s57, 0xbfb8aa3b
    v_mul_f32 v28, s57, v24
    v_mul_f32 v29, s57, v25
    v_mul_f32 v30, s57, v26
    v_mul_f32 v31, s57, v27
    v_exp_f32 v28, v28
    v_exp_f32 v29, v29
    v_exp_f32 v30, v30
    v_exp_f32 v31, v31
    s_nop 0
    v_add_f32 v28, 1.0, v28
    v_add_f32 v29, 1.0, v29
    v_add_f32 v30, 1.0, v30
    v_add_f32 v31, 1.0, v31
    v_rcp_f32 v28, v28
    v_rcp_f32 v29, v29
    v_rcp_f32 v30, v30
    v_rcp_f32 v31, v31
    s_nop 0
    v_mul_f32 v24, v24, v28
    v_mul_f32 v25, v25, v29
    v_mul_f32 v26, v26, v30
    v_mul_f32 v27, v27, v31
    v_cvt_pk_bf16_f32 v8, v24, v25
    v_cvt_pk_bf16_f32 v9, v26, v27
    v_lshlrev_b32 v24, 16, v8
    v_and_b32 v25, s96, v8
    v_lshlrev_b32 v26, 16, v9
    v_and_b32 v27, s96, v9
    v_lshlrev_b32 v28, 16, v20
    v_and_b32 v29, s96, v20
    v_lshlrev_b32 v30, 16, v21
    v_and_b32 v31, s96, v21
    s_mov_b64 exec, 3
    ds_write_b128 v6, v[24:27]
    ds_write_b128 v6, v[28:31] offset:16
    s_waitcnt lgkmcnt(0)
    s_barrier
    s_endpgm
L_fins:
    s_add_u32 s55, s52, 1376256
    s_mov_b32 s36, s20
    s_mov_b32 s37, s21
    s_mov_b32 s38, 4096
    s_mov_b32 s39, 0x20000
    v_lshlrev_b32 v7, 2, v1
    v_add_u32 v6, v6, v7
    v_lshl_add_u32 v5, v1, 1, v5
    s_mov_b32 s62, 0x00030003
    s_mov_b32 s63, 0x00030003
    s_mov_b32 s69, 200000
L_psp_7:
    buffer_load_dwordx4 v[32:35], v3, s[40:43], s55 offen sc1
    s_waitcnt vmcnt(0)
    v_cmp_ne_u32 s[64:65], s31, v33
    v_cmp_ne_u32 vcc, s31, v35
    s_or_b64 vcc, vcc, s[64:65]
    s_cmp_eq_u64 vcc, 0
    s_cbranch_scc1 L_psp_7_d
    s_sub_u32 s69, s69, 1
    s_cbranch_scc1 L_psp_7_d
    s_mov_b64 exec, vcc
    s_sleep 1
    s_branch L_psp_7
L_psp_7_d:
    s_mov_b64 exec, -1
    v_lshlrev_b32 v40, 16, v32
    v_and_b32 v41, s96, v32
    v_lshlrev_b32 v42, 16, v34
    v_and_b32 v43, s96, v34
    s_nop 0
    v_permlane32_swap_b32 v40, v42
    v_permlane32_swap_b32 v41, v43
    s_nop 0
    v_add_f32 v40, v40, v42
    v_add_f32 v41, v41, v43
    s_nop 1
    v_permlane16_swap_b32 v40, v41
    s_nop 1
    v_add_f32 v40, v40, v41
    s_nop 1
    v_add_f32_dpp v40, v40, v40 row_ror:2 row_mask:0xf bank_mask:0xf
    s_nop 1
    v_add_f32_dpp v40, v40, v40 row_ror:4 row_mask:0xf bank_mask:0xf
    s_nop 1
    v_add_f32_dpp v40, v40, v40 row_ror:8 row_mask:0xf bank_mask:0xf
    s_barrier
    ds_read2_b32 v[24:25], v6 offset0:0 offset1:4
    v_cvt_pk_bf16_f32 v8, v40, v40
    v_lshlrev_b32 v40, 16, v8
    s_waitcnt lgkmcnt(0)
    v_mul_f32 v40, v40, v24
    v_cvt_pk_bf16_f32 v8, v40, v40
    v_lshlrev_b32 v40, 16, v8
    v_add_f32 v40, v40, v25
    v_cvt_pk_bf16_f32 v8, v40, v40
    s_mov_b64 exec, s[62:63]
    buffer_store_short v8, v5, s[36:39], s56 offen
    s_cmp_eq_u32 s2, 0
    s_cbranch_scc0 L_noep
    s_mov_b64 exec, 1
    v_mov_b32 v6, 0
    v_mov_b32 v7, s31
    buffer_store_dword v7, v6, s[40:43], 0 offen
L_noep:
L_end:
    s_endpgm
.fill (16384 - (. - recurrent_scan__sliding_block_cached__dense_activation_relu__decode_kernel)) / 4, 4, 0xbf800000
.section .rodata,"a"
.p2align 6
.amdhsa_kernel recurrent_scan__sliding_block_cached__dense_activation_relu__decode_kernel
.amdhsa_next_free_vgpr 256
.amdhsa_next_free_sgpr 102
.amdhsa_accum_offset 256
.amdhsa_group_segment_fixed_size 0
.amdhsa_kernarg_size 88
.amdhsa_user_sgpr_count 2
.amdhsa_user_sgpr_kernarg_segment_ptr 1
.amdhsa_system_sgpr_workgroup_id_x 1
.end_amdhsa_kernel
```
